```python
import torch

def _softmax(x, axis=-1):
    return torch.softmax(x, dim=axis)
def _gelu(x):
    return torch.nn.functional.gelu(x, approximate="tanh")
def _silu(x):
    return torch.nn.functional.silu(x)
def _sigmoid(x):
    return torch.sigmoid(x)
def _layernorm(x, axis=-1, eps=1e-5):
    m = x.mean(dim=axis, keepdim=True)
    v = x.var(dim=axis, keepdim=True, unbiased=False)
    return (x - m) / torch.sqrt(v + eps)
def _scatter_add(tgt, idx, src, axis=0):
    return tgt.clone().index_add_(axis, idx, src)
def _segment_sum(src, seg, n):
    out = torch.zeros((n,) + src.shape[1:], dtype=src.dtype)
    return out.index_add_(0, seg, src)
def _pad(x, pw):
    flat = tuple(v for pair in reversed(pw) for v in pair)
    return torch.nn.functional.pad(x, flat)

kernel_name = 'sequential_preLN__grouped_kv_mqa__dense_activation_mish__prompt'

def setup_inputs():

    _w = (lambda a: (lambda t: t.to(torch.bfloat16) if t.is_floating_point() else t)(torch.as_tensor(a)))
    def _A_setup():
        B, S, D, H = 1, 2048, 512, 32
        Dh = D // H
        return {
            "x": _w((lambda *s: torch.randn(*s, dtype=torch.bfloat16) * 0.05)(B, S, D)),
            "wq": _w((lambda *s: torch.randn(*s, dtype=torch.bfloat16) * 0.05)(D, H * Dh)),
            "wk": _w((lambda *s: torch.randn(*s, dtype=torch.bfloat16) * 0.05)(D, Dh)),
            "wv": _w((lambda *s: torch.randn(*s, dtype=torch.bfloat16) * 0.05)(D, Dh)),
            "wo": _w((lambda *s: torch.randn(*s, dtype=torch.bfloat16) * 0.05)(H * Dh, D)),
        }
    _A_in = _A_setup()

    def _B_setup():
        B, S, D, F = 1, 2048, 512, 1792
        return {
            "x": _w((lambda *s: torch.randn(*s, dtype=torch.bfloat16) * 0.05)(B, S, D)),
            "w1": _w((lambda *s: torch.randn(*s, dtype=torch.bfloat16) * 0.8)(D, F) * (D ** -0.5)),
            "b1": _w((lambda *s: torch.randn(*s, dtype=torch.bfloat16) * 0.4)(F)),
            "w2": _w((lambda *s: torch.randn(*s, dtype=torch.bfloat16) * 0.2)(F, D) * (F ** -0.5)),
        }
    _B_in = _B_setup()

    return {
        "A_x": _A_in["x"],
        "A_wq": _A_in["wq"],
        "A_wk": _A_in["wk"],
        "A_wv": _A_in["wv"],
        "A_wo": _A_in["wo"],
        "B_x": _B_in["x"],
        "B_w1": _B_in["w1"],
        "B_b1": _B_in["b1"],
        "B_w2": _B_in["w2"],
    }

def reference(A_x, A_wq, A_wk, A_wv, A_wo, B_x, B_w1, B_b1, B_w2):
    def _A_ref(x, wq, wk, wv, wo):
        B, S, D = x.shape
        H = 32
        Dh = D // H
        q = (lambda x, *d: x.permute(*d))((x @ wq).reshape(B, S, H, Dh), 0, 2, 1, 3)
        k = x @ wk
        v = x @ wv
        scores = torch.einsum("bhqd,bkd->bhqk", q, k) * (Dh ** -0.5)
        p = _softmax(scores, axis=-1)
        o = torch.einsum("bhqk,bkd->bhqd", p, v)
        return (lambda x, *d: x.permute(*d))(o, 0, 2, 1, 3).reshape(B, S, H * Dh) @ wo

    def _B_ref(x, w1, b1, w2):
        h = torch.einsum("bsd,df->bsf", x, w1) + b1
        sp = torch.log1p(torch.exp(-torch.abs(h))) + torch.where(h > 0, h, torch.zeros_like(h))
        act = h * torch.tanh(sp)
        return torch.einsum("bsf,fd->bsd", act, w2)

    x = A_x
    h = x + _A_ref(_layernorm(x, axis=-1), A_wq, A_wk, A_wv, A_wo)
    h2 = h + _B_ref(_layernorm(h, axis=-1), B_w1, B_b1, B_w2)
    return h2
```

```asm
; @launch grid=(256,1,1) block=(512,1,1) lds=163840
.amdgcn_target "amdgcn-amd-amdhsa--gfx950"
.text
.globl sequential_preLN__grouped_kv_mqa__dense_activation_mish__prompt_kernel
.p2align 8
.type sequential_preLN__grouped_kv_mqa__dense_activation_mish__prompt_kernel,@function
sequential_preLN__grouped_kv_mqa__dense_activation_mish__prompt_kernel:
    s_cmp_ge_u32 s2, 256
    s_cbranch_scc1 L_end
    s_load_dwordx16 s[64:79], s[0:1], 0
    s_load_dwordx8 s[80:87], s[0:1], 64
    v_lshrrev_b32 v2, 6, v0
    v_and_b32 v1, 63, v0
    v_readfirstlane_b32 s42, v2
    v_lshlrev_b32 v2, 4, v1
    s_lshr_b32 s40, s2, 3
    s_and_b32 s40, s40, 7
    s_and_b32 s41, s2, 7
    s_lshl_b32 s41, s41, 2
    s_lshr_b32 s3, s2, 6
    s_add_u32 s41, s41, s3
    s_getreg_b32 s17, hwreg(HW_REG_XCC_ID, 0, 4)
    s_waitcnt lgkmcnt(0)
    s_load_dword s16, s[86:87], 0x37000
    s_mov_b32 s4, s64
    s_mov_b32 s5, s65
    s_mov_b32 s6, 0x200000
    s_mov_b32 s7, 0x20000
    s_bitcmp1_b32 s40, 0
    s_cselect_b32 s12, s70, s68
    s_cselect_b32 s13, s71, s69
    s_mov_b32 s14, 0x4000
    s_mov_b32 s15, 0x20000
    s_mov_b32 s8, s66
    s_mov_b32 s9, s67
    s_mov_b32 s10, 0x80000
    s_mov_b32 s11, 0x20000
    s_mov_b32 s36, s86
    s_mov_b32 s37, s87
    s_mov_b32 s38, 0x1e00000
    s_mov_b32 s39, 0x20000
    s_mov_b32 s24, s78
    s_mov_b32 s25, s79
    s_mov_b32 s26, 0xe00
    s_mov_b32 s27, 0x20000
    s_mov_b32 s32, s82
    s_mov_b32 s33, s83
    s_mov_b32 s34, 0x200000
    s_mov_b32 s35, 0x20000
    s_lshr_b32 s47, s40, 1
    s_lshl_b32 s47, s47, 4
    s_lshl_b32 s88, s42, 1
    s_add_u32 s88, s88, s47
    s_add_u32 s89, s88, 1
    s_lshl_b32 s48, s41, 16
    s_lshl_b32 s43, s88, 10
    s_add_u32 s43, s43, s48
    buffer_load_dwordx4 v[32:35], v2, s[4:7], s43 offen
    s_lshl_b32 s43, s89, 10
    s_add_u32 s43, s43, s48
    buffer_load_dwordx4 v[36:39], v2, s[4:7], s43 offen
    s_lshl_b32 s43, s42, 11
    s_mov_b32 m0, s43
    s_nop 0
    buffer_load_dwordx4 v2, s[12:15], s43 offen lds
    buffer_load_dwordx4 v2, s[12:15], s43 offen offset:1024 lds
    s_mov_b32 s44, 0x3f803f80
    s_mov_b32 s45, 0x3b000000
    s_mov_b32 s46, 0x3727c5ac
    s_cmp_lt_u32 s2, 112
    s_cbranch_scc1 L_tb_w1
    s_cmp_lt_u32 s2, 224
    s_cbranch_scc1 L_tb_w2
    s_sub_u32 s3, s2, 224
    s_mov_b32 s52, s72
    s_mov_b32 s53, s73
    s_mov_b32 s54, 0x80000
    s_mov_b32 s56, 1024
    s_and_b32 s60, s3, 3
    s_lshr_b32 s61, s3, 2
    s_mov_b32 s59, 32768
    s_mov_b32 s62, 0x240000
    s_branch L_tb_go
L_tb_w1:
    s_mov_b32 s52, s76
    s_mov_b32 s53, s77
    s_mov_b32 s54, 0x1c0000
    s_mov_b32 s56, 3584
    s_and_b32 s60, s2, 3
    s_lshr_b32 s61, s2, 2
    s_mov_b32 s59, 32768
    s_mov_b32 s62, 0x2c0000
    s_branch L_tb_go
L_tb_w2:
    s_sub_u32 s3, s2, 112
    s_mov_b32 s52, s80
    s_mov_b32 s53, s81
    s_mov_b32 s54, 0x1c0000
    s_mov_b32 s56, 1024
    s_lshr_b32 s60, s3, 3
    s_and_b32 s61, s3, 7
    s_mov_b32 s59, 114688
    s_mov_b32 s62, 0x480000
L_tb_go:
    s_mov_b32 s55, 0x20000
    s_lshl_b32 s3, s60, 7
    s_lshl_b32 s43, s42, 4
    s_add_u32 s3, s3, s43
    s_mul_i32 s57, s3, s56
    s_lshl_b32 s3, s61, 7
    s_add_u32 s57, s57, s3
    s_lshl_b32 s3, s61, 1
    s_mul_i32 s58, s3, s59
    s_add_u32 s58, s58, s62
    s_lshl_b32 s3, s60, 3
    s_add_u32 s3, s3, s42
    s_lshl_b32 s3, s3, 10
    s_add_u32 s58, s58, s3
    s_lshl_b32 s60, s42, 11
    s_cmp_lt_u32 s42, 4
    s_mov_b32 s3, 148480
    s_cselect_b32 s3, s3, 0xfffff000
    s_add_u32 s60, s60, s3
    v_lshrrev_b32 v3, 3, v1
    v_and_b32 v4, 7, v1
    v_lshlrev_b32 v5, 1, v3
    v_and_b32 v5, 4, v5
    v_xor_b32 v4, v4, v5
    v_lshlrev_b32 v4, 4, v4
    v_lshl_add_u32 v5, v3, 10, v4
    s_waitcnt vmcnt(2) lgkmcnt(0)
    s_cmp_eq_u32 s42, 7
    s_cbranch_scc1 L_p1_noq
    s_mul_i32 s90, s42, 7
    s_add_u32 s90, s90, 0
    s_add_u32 s43, s90, 16
    s_cmp_lt_u32 s90, s47
    s_cselect_b32 s90, s90, s43
    s_lshl_b32 s43, s90, 10
    s_add_u32 s43, s43, s48
    buffer_load_dwordx4 v[40:43], v2, s[4:7], s43 offen
    s_mul_i32 s91, s42, 7
    s_add_u32 s91, s91, 1
    s_add_u32 s43, s91, 16
    s_cmp_lt_u32 s91, s47
    s_cselect_b32 s91, s91, s43
    s_lshl_b32 s43, s91, 10
    s_add_u32 s43, s43, s48
    buffer_load_dwordx4 v[44:47], v2, s[4:7], s43 offen
    s_mul_i32 s92, s42, 7
    s_add_u32 s92, s92, 2
    s_add_u32 s43, s92, 16
    s_cmp_lt_u32 s92, s47
    s_cselect_b32 s92, s92, s43
    s_lshl_b32 s43, s92, 10
    s_add_u32 s43, s43, s48
    buffer_load_dwordx4 v[48:51], v2, s[4:7], s43 offen
    s_mul_i32 s93, s42, 7
    s_add_u32 s93, s93, 3
    s_add_u32 s43, s93, 16
    s_cmp_lt_u32 s93, s47
    s_cselect_b32 s93, s93, s43
    s_lshl_b32 s43, s93, 10
    s_add_u32 s43, s43, s48
    buffer_load_dwordx4 v[52:55], v2, s[4:7], s43 offen
    s_mul_i32 s94, s42, 7
    s_add_u32 s94, s94, 4
    s_add_u32 s43, s94, 16
    s_cmp_lt_u32 s94, s47
    s_cselect_b32 s94, s94, s43
    s_lshl_b32 s43, s94, 10
    s_add_u32 s43, s43, s48
    buffer_load_dwordx4 v[56:59], v2, s[4:7], s43 offen
    s_mul_i32 s95, s42, 7
    s_add_u32 s95, s95, 5
    s_add_u32 s43, s95, 16
    s_cmp_lt_u32 s95, s47
    s_cselect_b32 s95, s95, s43
    s_lshl_b32 s43, s95, 10
    s_add_u32 s43, s43, s48
    buffer_load_dwordx4 v[60:63], v2, s[4:7], s43 offen
    s_mul_i32 s63, s42, 7
    s_add_u32 s63, s63, 6
    s_min_u32 s63, s63, 47
    s_add_u32 s43, s63, 16
    s_cmp_lt_u32 s63, s47
    s_cselect_b32 s63, s63, s43
    s_lshl_b32 s43, s63, 10
    s_add_u32 s43, s43, s48
    buffer_load_dwordx4 v[64:67], v2, s[4:7], s43 offen
L_p1_noq:
    s_mul_i32 s100, s16, 0x9E3779B1
    s_add_u32 s100, s100, 0x7F4A7C15
    s_and_b32 s100, s100, 0xFFFFFFF0
    s_or_b32 s17, s17, s100
    s_add_u32 s16, s16, 1
    v_dot2_f32_bf16 v8, v32, s44, 0
    v_dot2_f32_bf16 v16, v32, v32, 0
    v_dot2_f32_bf16 v9, v36, s44, 0
    v_dot2_f32_bf16 v17, v36, v36, 0
    v_dot2_f32_bf16 v8, v33, s44, v8
    v_dot2_f32_bf16 v16, v33, v33, v16
    v_dot2_f32_bf16 v9, v37, s44, v9
    v_dot2_f32_bf16 v17, v37, v37, v17
    v_dot2_f32_bf16 v8, v34, s44, v8
    v_dot2_f32_bf16 v16, v34, v34, v16
    v_dot2_f32_bf16 v9, v38, s44, v9
    v_dot2_f32_bf16 v17, v38, v38, v17
    v_dot2_f32_bf16 v8, v35, s44, v8
    v_dot2_f32_bf16 v16, v35, v35, v16
    v_dot2_f32_bf16 v9, v39, s44, v9
    v_dot2_f32_bf16 v17, v39, v39, v17
    s_nop 1
    v_permlane32_swap_b32 v8, v9
    v_permlane32_swap_b32 v16, v17
    v_add_f32 v8, v8, v9
    v_add_f32 v16, v16, v17
    v_mov_b32 v9, v8
    v_mov_b32 v17, v16
    s_nop 0
    v_permlane16_swap_b32 v8, v9
    v_permlane16_swap_b32 v16, v17
    v_add_f32 v8, v8, v9
    v_add_f32 v16, v16, v17
    s_nop 0
    v_add_f32_dpp v8, v8, v8 row_ror:8 row_mask:0xf bank_mask:0xf
    v_add_f32_dpp v16, v16, v16 row_ror:8 row_mask:0xf bank_mask:0xf
    s_nop 0
    v_add_f32_dpp v8, v8, v8 row_ror:4 row_mask:0xf bank_mask:0xf
    v_add_f32_dpp v16, v16, v16 row_ror:4 row_mask:0xf bank_mask:0xf
    s_nop 0
    v_add_f32_dpp v8, v8, v8 row_ror:2 row_mask:0xf bank_mask:0xf
    v_add_f32_dpp v16, v16, v16 row_ror:2 row_mask:0xf bank_mask:0xf
    s_nop 0
    v_add_f32_dpp v8, v8, v8 row_ror:1 row_mask:0xf bank_mask:0xf
    v_add_f32_dpp v16, v16, v16 row_ror:1 row_mask:0xf bank_mask:0xf
    v_mul_f32 v8, s45, v8
    v_mul_f32 v9, v8, v8
    v_fma_f32 v16, v16, s45, -v9
    v_add_f32 v16, s46, v16
    v_rsq_f32 v16, v16
    s_nop 0
    v_mul_f32_e64 v8, -v8, v16
    v_readlane_b32 s72, v16, 0
    v_readlane_b32 s73, v8, 0
    v_readlane_b32 s74, v16, 32
    v_readlane_b32 s75, v8, 32
    v_lshlrev_b32 v24, 16, v32
    v_and_b32 v25, 0xffff0000, v32
    v_lshlrev_b32 v26, 16, v33
    v_and_b32 v27, 0xffff0000, v33
    v_lshlrev_b32 v28, 16, v34
    v_and_b32 v29, 0xffff0000, v34
    v_lshlrev_b32 v30, 16, v35
    v_and_b32 v31, 0xffff0000, v35
    v_pk_fma_f32 v[24:25], v[24:25], s[72:73], s[72:73] op_sel:[0,0,1] op_sel_hi:[1,0,1]
    v_pk_fma_f32 v[26:27], v[26:27], s[72:73], s[72:73] op_sel:[0,0,1] op_sel_hi:[1,0,1]
    v_pk_fma_f32 v[28:29], v[28:29], s[72:73], s[72:73] op_sel:[0,0,1] op_sel_hi:[1,0,1]
    v_pk_fma_f32 v[30:31], v[30:31], s[72:73], s[72:73] op_sel:[0,0,1] op_sel_hi:[1,0,1]
    v_cvt_pk_bf16_f32 v32, v24, v25
    v_cvt_pk_bf16_f32 v33, v26, v27
    v_cvt_pk_bf16_f32 v34, v28, v29
    v_cvt_pk_bf16_f32 v35, v30, v31
    s_lshl_b32 s3, s88, 10
    s_and_b32 s43, s88, 15
    s_lshl_b32 s43, s43, 4
    s_add_u32 s3, s3, s43
    s_add_u32 s3, s3, 32768
    v_xor_b32 v7, s3, v2
    ds_write_b128 v7, v[32:35]
    v_lshlrev_b32 v24, 16, v36
    v_and_b32 v25, 0xffff0000, v36
    v_lshlrev_b32 v26, 16, v37
    v_and_b32 v27, 0xffff0000, v37
    v_lshlrev_b32 v28, 16, v38
    v_and_b32 v29, 0xffff0000, v38
    v_lshlrev_b32 v30, 16, v39
    v_and_b32 v31, 0xffff0000, v39
    v_pk_fma_f32 v[24:25], v[24:25], s[74:75], s[74:75] op_sel:[0,0,1] op_sel_hi:[1,0,1]
    v_pk_fma_f32 v[26:27], v[26:27], s[74:75], s[74:75] op_sel:[0,0,1] op_sel_hi:[1,0,1]
    v_pk_fma_f32 v[28:29], v[28:29], s[74:75], s[74:75] op_sel:[0,0,1] op_sel_hi:[1,0,1]
    v_pk_fma_f32 v[30:31], v[30:31], s[74:75], s[74:75] op_sel:[0,0,1] op_sel_hi:[1,0,1]
    v_cvt_pk_bf16_f32 v36, v24, v25
    v_cvt_pk_bf16_f32 v37, v26, v27
    v_cvt_pk_bf16_f32 v38, v28, v29
    v_cvt_pk_bf16_f32 v39, v30, v31
    s_lshl_b32 s3, s89, 10
    s_and_b32 s43, s89, 15
    s_lshl_b32 s43, s43, 4
    s_add_u32 s3, s3, s43
    s_add_u32 s3, s3, 32768
    v_xor_b32 v7, s3, v2
    ds_write_b128 v7, v[36:39]
    s_cmp_eq_u32 s42, 7
    s_cbranch_scc1 L_p1_w7b
    s_waitcnt vmcnt(7) lgkmcnt(0)
    s_barrier
    s_lshl_b32 s49, s42, 13
    s_lshl_b32 s43, s40, 7
    s_add_u32 s49, s49, s43
    s_lshl_b32 s50, s42, 10
    s_add_u32 s50, s50, 98304
    s_mov_b32 m0, s50
    s_add_u32 s50, s50, 7168
    buffer_load_dwordx4 v5, s[8:11], s49 offen lds
    s_add_u32 s49, s49, 57344
    s_mov_b32 m0, s50
    s_add_u32 s50, s50, 7168
    buffer_load_dwordx4 v5, s[8:11], s49 offen lds
    s_add_u32 s49, s49, 57344
    s_waitcnt vmcnt(5)
    v_dot2_f32_bf16 v8, v40, s44, 0
    v_dot2_f32_bf16 v16, v40, v40, 0
    v_dot2_f32_bf16 v9, v44, s44, 0
    v_dot2_f32_bf16 v17, v44, v44, 0
    v_dot2_f32_bf16 v10, v48, s44, 0
    v_dot2_f32_bf16 v18, v48, v48, 0
    v_dot2_f32_bf16 v11, v52, s44, 0
    v_dot2_f32_bf16 v19, v52, v52, 0
    v_dot2_f32_bf16 v8, v41, s44, v8
    v_dot2_f32_bf16 v16, v41, v41, v16
    v_dot2_f32_bf16 v9, v45, s44, v9
    v_dot2_f32_bf16 v17, v45, v45, v17
    v_dot2_f32_bf16 v10, v49, s44, v10
    v_dot2_f32_bf16 v18, v49, v49, v18
    v_dot2_f32_bf16 v11, v53, s44, v11
    v_dot2_f32_bf16 v19, v53, v53, v19
    v_dot2_f32_bf16 v8, v42, s44, v8
    v_dot2_f32_bf16 v16, v42, v42, v16
    v_dot2_f32_bf16 v9, v46, s44, v9
    v_dot2_f32_bf16 v17, v46, v46, v17
    v_dot2_f32_bf16 v10, v50, s44, v10
    v_dot2_f32_bf16 v18, v50, v50, v18
    v_dot2_f32_bf16 v11, v54, s44, v11
    v_dot2_f32_bf16 v19, v54, v54, v19
    v_dot2_f32_bf16 v8, v43, s44, v8
    v_dot2_f32_bf16 v16, v43, v43, v16
    v_dot2_f32_bf16 v9, v47, s44, v9
    v_dot2_f32_bf16 v17, v47, v47, v17
    v_dot2_f32_bf16 v10, v51, s44, v10
    v_dot2_f32_bf16 v18, v51, v51, v18
    v_dot2_f32_bf16 v11, v55, s44, v11
    v_dot2_f32_bf16 v19, v55, v55, v19
    v_permlane32_swap_b32 v8, v9
    s_nop 0
    v_permlane32_swap_b32 v10, v11
    v_permlane32_swap_b32 v16, v17
    v_permlane32_swap_b32 v18, v19
    v_add_f32 v8, v8, v9
    v_add_f32 v10, v10, v11
    v_add_f32 v16, v16, v17
    v_add_f32 v18, v18, v19
    v_permlane16_swap_b32 v8, v10
    s_nop 0
    v_permlane16_swap_b32 v16, v18
    v_add_f32 v8, v8, v10
    v_add_f32 v16, v16, v18
    s_nop 0
    v_add_f32_dpp v8, v8, v8 row_ror:8 row_mask:0xf bank_mask:0xf
    v_add_f32_dpp v16, v16, v16 row_ror:8 row_mask:0xf bank_mask:0xf
    s_nop 0
    v_add_f32_dpp v8, v8, v8 row_ror:4 row_mask:0xf bank_mask:0xf
    v_add_f32_dpp v16, v16, v16 row_ror:4 row_mask:0xf bank_mask:0xf
    s_nop 0
    v_add_f32_dpp v8, v8, v8 row_ror:2 row_mask:0xf bank_mask:0xf
    v_add_f32_dpp v16, v16, v16 row_ror:2 row_mask:0xf bank_mask:0xf
    s_nop 0
    v_add_f32_dpp v8, v8, v8 row_ror:1 row_mask:0xf bank_mask:0xf
    v_add_f32_dpp v16, v16, v16 row_ror:1 row_mask:0xf bank_mask:0xf
    v_mul_f32 v8, s45, v8
    v_mul_f32 v9, v8, v8
    v_fma_f32 v16, v16, s45, -v9
    v_add_f32 v16, s46, v16
    v_rsq_f32 v16, v16
    s_nop 0
    v_mul_f32_e64 v8, -v8, v16
    v_readlane_b32 s72, v16, 0
    v_readlane_b32 s73, v8, 0
    v_readlane_b32 s76, v16, 16
    v_readlane_b32 s77, v8, 16
    v_readlane_b32 s74, v16, 32
    v_readlane_b32 s75, v8, 32
    v_readlane_b32 s78, v16, 48
    v_readlane_b32 s79, v8, 48
    s_mov_b32 m0, s50
    s_add_u32 s50, s50, 7168
    buffer_load_dwordx4 v5, s[8:11], s49 offen lds
    s_add_u32 s49, s49, 57344
    s_mov_b32 m0, s50
    s_add_u32 s50, s50, 7168
    buffer_load_dwordx4 v5, s[8:11], s49 offen lds
    s_add_u32 s49, s49, 57344
    v_lshlrev_b32 v24, 16, v40
    v_and_b32 v25, 0xffff0000, v40
    v_lshlrev_b32 v26, 16, v41
    v_and_b32 v27, 0xffff0000, v41
    v_lshlrev_b32 v28, 16, v42
    v_and_b32 v29, 0xffff0000, v42
    v_lshlrev_b32 v30, 16, v43
    v_and_b32 v31, 0xffff0000, v43
    v_pk_fma_f32 v[24:25], v[24:25], s[72:73], s[72:73] op_sel:[0,0,1] op_sel_hi:[1,0,1]
    v_pk_fma_f32 v[26:27], v[26:27], s[72:73], s[72:73] op_sel:[0,0,1] op_sel_hi:[1,0,1]
    v_pk_fma_f32 v[28:29], v[28:29], s[72:73], s[72:73] op_sel:[0,0,1] op_sel_hi:[1,0,1]
    v_pk_fma_f32 v[30:31], v[30:31], s[72:73], s[72:73] op_sel:[0,0,1] op_sel_hi:[1,0,1]
    v_cvt_pk_bf16_f32 v40, v24, v25
    v_cvt_pk_bf16_f32 v41, v26, v27
    v_cvt_pk_bf16_f32 v42, v28, v29
    v_cvt_pk_bf16_f32 v43, v30, v31
    s_lshl_b32 s3, s90, 10
    s_and_b32 s43, s90, 15
    s_lshl_b32 s43, s43, 4
    s_add_u32 s3, s3, s43
    s_add_u32 s3, s3, 32768
    v_xor_b32 v7, s3, v2
    ds_write_b128 v7, v[40:43]
    v_lshlrev_b32 v24, 16, v44
    v_and_b32 v25, 0xffff0000, v44
    v_lshlrev_b32 v26, 16, v45
    v_and_b32 v27, 0xffff0000, v45
    v_lshlrev_b32 v28, 16, v46
    v_and_b32 v29, 0xffff0000, v46
    v_lshlrev_b32 v30, 16, v47
    v_and_b32 v31, 0xffff0000, v47
    v_pk_fma_f32 v[24:25], v[24:25], s[74:75], s[74:75] op_sel:[0,0,1] op_sel_hi:[1,0,1]
    v_pk_fma_f32 v[26:27], v[26:27], s[74:75], s[74:75] op_sel:[0,0,1] op_sel_hi:[1,0,1]
    v_pk_fma_f32 v[28:29], v[28:29], s[74:75], s[74:75] op_sel:[0,0,1] op_sel_hi:[1,0,1]
    v_pk_fma_f32 v[30:31], v[30:31], s[74:75], s[74:75] op_sel:[0,0,1] op_sel_hi:[1,0,1]
    v_cvt_pk_bf16_f32 v44, v24, v25
    v_cvt_pk_bf16_f32 v45, v26, v27
    v_cvt_pk_bf16_f32 v46, v28, v29
    v_cvt_pk_bf16_f32 v47, v30, v31
    s_lshl_b32 s3, s91, 10
    s_and_b32 s43, s91, 15
    s_lshl_b32 s43, s43, 4
    s_add_u32 s3, s3, s43
    s_add_u32 s3, s3, 32768
    v_xor_b32 v7, s3, v2
    ds_write_b128 v7, v[44:47]
    s_mov_b32 m0, s50
    s_add_u32 s50, s50, 7168
    buffer_load_dwordx4 v5, s[8:11], s49 offen lds
    s_add_u32 s49, s49, 57344
    v_lshlrev_b32 v24, 16, v48
    v_and_b32 v25, 0xffff0000, v48
    v_lshlrev_b32 v26, 16, v49
    v_and_b32 v27, 0xffff0000, v49
    v_lshlrev_b32 v28, 16, v50
    v_and_b32 v29, 0xffff0000, v50
    v_lshlrev_b32 v30, 16, v51
    v_and_b32 v31, 0xffff0000, v51
    v_pk_fma_f32 v[24:25], v[24:25], s[76:77], s[76:77] op_sel:[0,0,1] op_sel_hi:[1,0,1]
    v_pk_fma_f32 v[26:27], v[26:27], s[76:77], s[76:77] op_sel:[0,0,1] op_sel_hi:[1,0,1]
    v_pk_fma_f32 v[28:29], v[28:29], s[76:77], s[76:77] op_sel:[0,0,1] op_sel_hi:[1,0,1]
    v_pk_fma_f32 v[30:31], v[30:31], s[76:77], s[76:77] op_sel:[0,0,1] op_sel_hi:[1,0,1]
    v_cvt_pk_bf16_f32 v48, v24, v25
    v_cvt_pk_bf16_f32 v49, v26, v27
    v_cvt_pk_bf16_f32 v50, v28, v29
    v_cvt_pk_bf16_f32 v51, v30, v31
    s_lshl_b32 s3, s92, 10
    s_and_b32 s43, s92, 15
    s_lshl_b32 s43, s43, 4
    s_add_u32 s3, s3, s43
    s_add_u32 s3, s3, 32768
    v_xor_b32 v7, s3, v2
    ds_write_b128 v7, v[48:51]
    v_lshlrev_b32 v24, 16, v52
    v_and_b32 v25, 0xffff0000, v52
    v_lshlrev_b32 v26, 16, v53
    v_and_b32 v27, 0xffff0000, v53
    v_lshlrev_b32 v28, 16, v54
    v_and_b32 v29, 0xffff0000, v54
    v_lshlrev_b32 v30, 16, v55
    v_and_b32 v31, 0xffff0000, v55
    v_pk_fma_f32 v[24:25], v[24:25], s[78:79], s[78:79] op_sel:[0,0,1] op_sel_hi:[1,0,1]
    v_pk_fma_f32 v[26:27], v[26:27], s[78:79], s[78:79] op_sel:[0,0,1] op_sel_hi:[1,0,1]
    v_pk_fma_f32 v[28:29], v[28:29], s[78:79], s[78:79] op_sel:[0,0,1] op_sel_hi:[1,0,1]
    v_pk_fma_f32 v[30:31], v[30:31], s[78:79], s[78:79] op_sel:[0,0,1] op_sel_hi:[1,0,1]
    v_cvt_pk_bf16_f32 v52, v24, v25
    v_cvt_pk_bf16_f32 v53, v26, v27
    v_cvt_pk_bf16_f32 v54, v28, v29
    v_cvt_pk_bf16_f32 v55, v30, v31
    s_lshl_b32 s3, s93, 10
    s_and_b32 s43, s93, 15
    s_lshl_b32 s43, s43, 4
    s_add_u32 s3, s3, s43
    s_add_u32 s3, s3, 32768
    v_xor_b32 v7, s3, v2
    ds_write_b128 v7, v[52:55]
    s_mov_b32 m0, s50
    s_add_u32 s50, s50, 7168
    buffer_load_dwordx4 v5, s[8:11], s49 offen lds
    s_add_u32 s49, s49, 57344
    s_waitcnt vmcnt(6)
    v_dot2_f32_bf16 v8, v56, s44, 0
    v_dot2_f32_bf16 v16, v56, v56, 0
    v_dot2_f32_bf16 v9, v60, s44, 0
    v_dot2_f32_bf16 v17, v60, v60, 0
    v_dot2_f32_bf16 v10, v64, s44, 0
    v_dot2_f32_bf16 v18, v64, v64, 0
    v_dot2_f32_bf16 v11, v52, s44, 0
    v_dot2_f32_bf16 v19, v52, v52, 0
    v_dot2_f32_bf16 v8, v57, s44, v8
    v_dot2_f32_bf16 v16, v57, v57, v16
    v_dot2_f32_bf16 v9, v61, s44, v9
    v_dot2_f32_bf16 v17, v61, v61, v17
    v_dot2_f32_bf16 v10, v65, s44, v10
    v_dot2_f32_bf16 v18, v65, v65, v18
    v_dot2_f32_bf16 v11, v53, s44, v11
    v_dot2_f32_bf16 v19, v53, v53, v19
    v_dot2_f32_bf16 v8, v58, s44, v8
    v_dot2_f32_bf16 v16, v58, v58, v16
    v_dot2_f32_bf16 v9, v62, s44, v9
    v_dot2_f32_bf16 v17, v62, v62, v17
    v_dot2_f32_bf16 v10, v66, s44, v10
    v_dot2_f32_bf16 v18, v66, v66, v18
    v_dot2_f32_bf16 v11, v54, s44, v11
    v_dot2_f32_bf16 v19, v54, v54, v19
    v_dot2_f32_bf16 v8, v59, s44, v8
    v_dot2_f32_bf16 v16, v59, v59, v16
    v_dot2_f32_bf16 v9, v63, s44, v9
    v_dot2_f32_bf16 v17, v63, v63, v17
    v_dot2_f32_bf16 v10, v67, s44, v10
    v_dot2_f32_bf16 v18, v67, v67, v18
    v_dot2_f32_bf16 v11, v55, s44, v11
    v_dot2_f32_bf16 v19, v55, v55, v19
    v_permlane32_swap_b32 v8, v9
    s_nop 0
    v_permlane32_swap_b32 v10, v11
    v_permlane32_swap_b32 v16, v17
    v_permlane32_swap_b32 v18, v19
    v_add_f32 v8, v8, v9
    v_add_f32 v10, v10, v11
    v_add_f32 v16, v16, v17
    v_add_f32 v18, v18, v19
    v_permlane16_swap_b32 v8, v10
    s_nop 0
    v_permlane16_swap_b32 v16, v18
    v_add_f32 v8, v8, v10
    v_add_f32 v16, v16, v18
    s_nop 0
    v_add_f32_dpp v8, v8, v8 row_ror:8 row_mask:0xf bank_mask:0xf
    v_add_f32_dpp v16, v16, v16 row_ror:8 row_mask:0xf bank_mask:0xf
    s_nop 0
    v_add_f32_dpp v8, v8, v8 row_ror:4 row_mask:0xf bank_mask:0xf
    v_add_f32_dpp v16, v16, v16 row_ror:4 row_mask:0xf bank_mask:0xf
    s_nop 0
    v_add_f32_dpp v8, v8, v8 row_ror:2 row_mask:0xf bank_mask:0xf
    v_add_f32_dpp v16, v16, v16 row_ror:2 row_mask:0xf bank_mask:0xf
    s_nop 0
    v_add_f32_dpp v8, v8, v8 row_ror:1 row_mask:0xf bank_mask:0xf
    v_add_f32_dpp v16, v16, v16 row_ror:1 row_mask:0xf bank_mask:0xf
    v_mul_f32 v8, s45, v8
    v_mul_f32 v9, v8, v8
    v_fma_f32 v16, v16, s45, -v9
    v_add_f32 v16, s46, v16
    v_rsq_f32 v16, v16
    s_nop 0
    v_mul_f32_e64 v8, -v8, v16
    v_readlane_b32 s72, v16, 0
    v_readlane_b32 s73, v8, 0
    v_readlane_b32 s76, v16, 16
    v_readlane_b32 s77, v8, 16
    v_readlane_b32 s74, v16, 32
    v_readlane_b32 s75, v8, 32
    v_readlane_b32 s78, v16, 48
    v_readlane_b32 s79, v8, 48
    s_mov_b32 m0, s50
    s_add_u32 s50, s50, 7168
    buffer_load_dwordx4 v5, s[8:11], s49 offen lds
    s_add_u32 s49, s49, 57344
    s_mov_b32 m0, s50
    s_add_u32 s50, s50, 7168
    buffer_load_dwordx4 v5, s[8:11], s49 offen lds
    s_add_u32 s49, s49, 57344
    v_lshlrev_b32 v24, 16, v56
    v_and_b32 v25, 0xffff0000, v56
    v_lshlrev_b32 v26, 16, v57
    v_and_b32 v27, 0xffff0000, v57
    v_lshlrev_b32 v28, 16, v58
    v_and_b32 v29, 0xffff0000, v58
    v_lshlrev_b32 v30, 16, v59
    v_and_b32 v31, 0xffff0000, v59
    v_pk_fma_f32 v[24:25], v[24:25], s[72:73], s[72:73] op_sel:[0,0,1] op_sel_hi:[1,0,1]
    v_pk_fma_f32 v[26:27], v[26:27], s[72:73], s[72:73] op_sel:[0,0,1] op_sel_hi:[1,0,1]
    v_pk_fma_f32 v[28:29], v[28:29], s[72:73], s[72:73] op_sel:[0,0,1] op_sel_hi:[1,0,1]
    v_pk_fma_f32 v[30:31], v[30:31], s[72:73], s[72:73] op_sel:[0,0,1] op_sel_hi:[1,0,1]
    v_cvt_pk_bf16_f32 v56, v24, v25
    v_cvt_pk_bf16_f32 v57, v26, v27
    v_cvt_pk_bf16_f32 v58, v28, v29
    v_cvt_pk_bf16_f32 v59, v30, v31
    s_lshl_b32 s3, s94, 10
    s_and_b32 s43, s94, 15
    s_lshl_b32 s43, s43, 4
    s_add_u32 s3, s3, s43
    s_add_u32 s3, s3, 32768
    v_xor_b32 v7, s3, v2
    ds_write_b128 v7, v[56:59]
    s_mov_b32 m0, s50
    s_add_u32 s50, s50, 7168
    buffer_load_dwordx4 v5, s[8:11], s49 offen lds
    s_add_u32 s49, s49, 57344
    v_lshlrev_b32 v24, 16, v60
    v_and_b32 v25, 0xffff0000, v60
    v_lshlrev_b32 v26, 16, v61
    v_and_b32 v27, 0xffff0000, v61
    v_lshlrev_b32 v28, 16, v62
    v_and_b32 v29, 0xffff0000, v62
    v_lshlrev_b32 v30, 16, v63
    v_and_b32 v31, 0xffff0000, v63
    v_pk_fma_f32 v[24:25], v[24:25], s[74:75], s[74:75] op_sel:[0,0,1] op_sel_hi:[1,0,1]
    v_pk_fma_f32 v[26:27], v[26:27], s[74:75], s[74:75] op_sel:[0,0,1] op_sel_hi:[1,0,1]
    v_pk_fma_f32 v[28:29], v[28:29], s[74:75], s[74:75] op_sel:[0,0,1] op_sel_hi:[1,0,1]
    v_pk_fma_f32 v[30:31], v[30:31], s[74:75], s[74:75] op_sel:[0,0,1] op_sel_hi:[1,0,1]
    v_cvt_pk_bf16_f32 v60, v24, v25
    v_cvt_pk_bf16_f32 v61, v26, v27
    v_cvt_pk_bf16_f32 v62, v28, v29
    v_cvt_pk_bf16_f32 v63, v30, v31
    s_lshl_b32 s3, s95, 10
    s_and_b32 s43, s95, 15
    s_lshl_b32 s43, s43, 4
    s_add_u32 s3, s3, s43
    s_add_u32 s3, s3, 32768
    v_xor_b32 v7, s3, v2
    ds_write_b128 v7, v[60:63]
    v_lshlrev_b32 v24, 16, v64
    v_and_b32 v25, 0xffff0000, v64
    v_lshlrev_b32 v26, 16, v65
    v_and_b32 v27, 0xffff0000, v65
    v_lshlrev_b32 v28, 16, v66
    v_and_b32 v29, 0xffff0000, v66
    v_lshlrev_b32 v30, 16, v67
    v_and_b32 v31, 0xffff0000, v67
    v_pk_fma_f32 v[24:25], v[24:25], s[76:77], s[76:77] op_sel:[0,0,1] op_sel_hi:[1,0,1]
    v_pk_fma_f32 v[26:27], v[26:27], s[76:77], s[76:77] op_sel:[0,0,1] op_sel_hi:[1,0,1]
    v_pk_fma_f32 v[28:29], v[28:29], s[76:77], s[76:77] op_sel:[0,0,1] op_sel_hi:[1,0,1]
    v_pk_fma_f32 v[30:31], v[30:31], s[76:77], s[76:77] op_sel:[0,0,1] op_sel_hi:[1,0,1]
    v_cvt_pk_bf16_f32 v64, v24, v25
    v_cvt_pk_bf16_f32 v65, v26, v27
    v_cvt_pk_bf16_f32 v66, v28, v29
    v_cvt_pk_bf16_f32 v67, v30, v31
    s_lshl_b32 s3, s63, 10
    s_and_b32 s43, s63, 15
    s_lshl_b32 s43, s43, 4
    s_add_u32 s3, s3, s43
    s_add_u32 s3, s3, 32768
    v_xor_b32 v7, s3, v2
    ds_write_b128 v7, v[64:67]
    s_cmp_lg_u32 s42, 0
    s_cbranch_scc1 L_p1_wq9
    s_mov_b32 m0, s50
    s_add_u32 s50, s50, 7168
    buffer_load_dwordx4 v5, s[8:11], s49 offen lds
    s_add_u32 s49, s49, 57344
L_p1_wq9:
    s_waitcnt vmcnt(0) lgkmcnt(0)
    s_barrier
    s_cmp_ge_u32 s42, 4
    s_cbranch_scc1 L_q_done
    s_and_b32 s48, s42, 1
    s_lshr_b32 s49, s42, 1
    v_lshrrev_b32 v8, 5, v1
    v_bfe_u32 v9, v1, 4, 1
    v_bfe_u32 v10, v1, 2, 2
    v_and_b32 v11, 3, v1
    v_lshrrev_b32 v12, 1, v11
    v_lshl_add_u32 v12, v9, 1, v12
    v_lshrrev_b32 v13, 1, v10
    v_lshlrev_b32 v13, 2, v13
    v_xor_b32 v12, v12, v13
    v_lshlrev_b32 v12, 4, v12
    v_and_b32 v11, 1, v11
    v_lshl_add_u32 v12, v11, 3, v12
    v_lshl_add_u32 v13, v8, 3, v10
    v_lshl_add_u32 v13, v13, 7, v12
    s_lshl_b32 s43, s48, 6
    v_xor_b32 v13, s43, v13
    v_add_u32 v13, 98304, v13
    v_and_b32 v16, 31, v1
    v_and_b32 v17, 15, v1
    v_xor_b32 v17, v17, v8
    v_lshlrev_b32 v17, 4, v17
    v_lshl_add_u32 v17, v16, 10, v17
    s_lshl_b32 s3, s49, 15
    s_add_u32 s3, s3, 32768
    v_add_u32 v24, s3, v17
    v_xor_b32 v25, 32, v24
    v_xor_b32 v26, 64, v24
    v_xor_b32 v27, 96, v24
    v_xor_b32 v28, 128, v24
    v_xor_b32 v29, 160, v24
    v_xor_b32 v30, 192, v24
    v_xor_b32 v31, 224, v24
    ds_read_b64_tr_b16 v[64:65], v13 offset:0
    ds_read_b64_tr_b16 v[66:67], v13 offset:512
    ds_read_b128 v[128:131], v24 offset:0
    ds_read_b64_tr_b16 v[68:69], v13 offset:2048
    ds_read_b64_tr_b16 v[70:71], v13 offset:2560
    ds_read_b128 v[132:135], v25 offset:0
    ds_read_b64_tr_b16 v[72:73], v13 offset:4096
    ds_read_b64_tr_b16 v[74:75], v13 offset:4608
    ds_read_b128 v[136:139], v26 offset:0
    ds_read_b64_tr_b16 v[76:77], v13 offset:6144
    ds_read_b64_tr_b16 v[78:79], v13 offset:6656
    ds_read_b128 v[140:143], v27 offset:0
    ds_read_b64_tr_b16 v[80:81], v13 offset:8192
    ds_read_b64_tr_b16 v[82:83], v13 offset:8704
    ds_read_b128 v[144:147], v28 offset:0
    s_waitcnt lgkmcnt(12)
    v_mfma_f32_32x32x16_bf16 v[32:47], v[64:67], v[128:131], 0
    ds_read_b64_tr_b16 v[84:85], v13 offset:10240
    ds_read_b64_tr_b16 v[86:87], v13 offset:10752
    ds_read_b128 v[148:151], v29 offset:0
    s_waitcnt lgkmcnt(12)
    v_mfma_f32_32x32x16_bf16 v[32:47], v[68:71], v[132:135], v[32:47]
    ds_read_b64_tr_b16 v[88:89], v13 offset:12288
    ds_read_b64_tr_b16 v[90:91], v13 offset:12800
    ds_read_b128 v[152:155], v30 offset:0
    s_waitcnt lgkmcnt(12)
    v_mfma_f32_32x32x16_bf16 v[32:47], v[72:75], v[136:139], v[32:47]
    ds_read_b64_tr_b16 v[92:93], v13 offset:14336
    ds_read_b64_tr_b16 v[94:95], v13 offset:14848
    ds_read_b128 v[156:159], v31 offset:0
    s_waitcnt lgkmcnt(12)
    v_mfma_f32_32x32x16_bf16 v[32:47], v[76:79], v[140:143], v[32:47]
    ds_read_b64_tr_b16 v[64:65], v13 offset:16384
    ds_read_b64_tr_b16 v[66:67], v13 offset:16896
    ds_read_b128 v[128:131], v24 offset:256
    s_waitcnt lgkmcnt(12)
    v_mfma_f32_32x32x16_bf16 v[32:47], v[80:83], v[144:147], v[32:47]
    ds_read_b64_tr_b16 v[68:69], v13 offset:18432
    ds_read_b64_tr_b16 v[70:71], v13 offset:18944
    ds_read_b128 v[132:135], v25 offset:256
    s_waitcnt lgkmcnt(12)
    v_mfma_f32_32x32x16_bf16 v[32:47], v[84:87], v[148:151], v[32:47]
    ds_read_b64_tr_b16 v[72:73], v13 offset:20480
    ds_read_b64_tr_b16 v[74:75], v13 offset:20992
    ds_read_b128 v[136:139], v26 offset:256
    s_waitcnt lgkmcnt(12)
    v_mfma_f32_32x32x16_bf16 v[32:47], v[88:91], v[152:155], v[32:47]
    ds_read_b64_tr_b16 v[76:77], v13 offset:22528
    ds_read_b64_tr_b16 v[78:79], v13 offset:23040
    ds_read_b128 v[140:143], v27 offset:256
    s_waitcnt lgkmcnt(12)
    v_mfma_f32_32x32x16_bf16 v[32:47], v[92:95], v[156:159], v[32:47]
    ds_read_b64_tr_b16 v[80:81], v13 offset:24576
    ds_read_b64_tr_b16 v[82:83], v13 offset:25088
    ds_read_b128 v[144:147], v28 offset:256
    s_waitcnt lgkmcnt(12)
    v_mfma_f32_32x32x16_bf16 v[32:47], v[64:67], v[128:131], v[32:47]
    ds_read_b64_tr_b16 v[84:85], v13 offset:26624
    ds_read_b64_tr_b16 v[86:87], v13 offset:27136
    ds_read_b128 v[148:151], v29 offset:256
    s_waitcnt lgkmcnt(12)
    v_mfma_f32_32x32x16_bf16 v[32:47], v[68:71], v[132:135], v[32:47]
    ds_read_b64_tr_b16 v[88:89], v13 offset:28672
    ds_read_b64_tr_b16 v[90:91], v13 offset:29184
    ds_read_b128 v[152:155], v30 offset:256
    s_waitcnt lgkmcnt(12)
    v_mfma_f32_32x32x16_bf16 v[32:47], v[72:75], v[136:139], v[32:47]
    ds_read_b64_tr_b16 v[92:93], v13 offset:30720
    ds_read_b64_tr_b16 v[94:95], v13 offset:31232
    ds_read_b128 v[156:159], v31 offset:256
    s_waitcnt lgkmcnt(12)
    v_mfma_f32_32x32x16_bf16 v[32:47], v[76:79], v[140:143], v[32:47]
    ds_read_b64_tr_b16 v[64:65], v13 offset:32768
    ds_read_b64_tr_b16 v[66:67], v13 offset:33280
    ds_read_b128 v[128:131], v24 offset:512
    s_waitcnt lgkmcnt(12)
    v_mfma_f32_32x32x16_bf16 v[32:47], v[80:83], v[144:147], v[32:47]
    ds_read_b64_tr_b16 v[68:69], v13 offset:34816
    ds_read_b64_tr_b16 v[70:71], v13 offset:35328
    ds_read_b128 v[132:135], v25 offset:512
    s_waitcnt lgkmcnt(12)
    v_mfma_f32_32x32x16_bf16 v[32:47], v[84:87], v[148:151], v[32:47]
    ds_read_b64_tr_b16 v[72:73], v13 offset:36864
    ds_read_b64_tr_b16 v[74:75], v13 offset:37376
    ds_read_b128 v[136:139], v26 offset:512
    s_waitcnt lgkmcnt(12)
    v_mfma_f32_32x32x16_bf16 v[32:47], v[88:91], v[152:155], v[32:47]
    ds_read_b64_tr_b16 v[76:77], v13 offset:38912
    ds_read_b64_tr_b16 v[78:79], v13 offset:39424
    ds_read_b128 v[140:143], v27 offset:512
    s_waitcnt lgkmcnt(12)
    v_mfma_f32_32x32x16_bf16 v[32:47], v[92:95], v[156:159], v[32:47]
    ds_read_b64_tr_b16 v[80:81], v13 offset:40960
    ds_read_b64_tr_b16 v[82:83], v13 offset:41472
    ds_read_b128 v[144:147], v28 offset:512
    s_waitcnt lgkmcnt(12)
    v_mfma_f32_32x32x16_bf16 v[32:47], v[64:67], v[128:131], v[32:47]
    ds_read_b64_tr_b16 v[84:85], v13 offset:43008
    ds_read_b64_tr_b16 v[86:87], v13 offset:43520
    ds_read_b128 v[148:151], v29 offset:512
    s_waitcnt lgkmcnt(12)
    v_mfma_f32_32x32x16_bf16 v[32:47], v[68:71], v[132:135], v[32:47]
    ds_read_b64_tr_b16 v[88:89], v13 offset:45056
    ds_read_b64_tr_b16 v[90:91], v13 offset:45568
    ds_read_b128 v[152:155], v30 offset:512
    s_waitcnt lgkmcnt(12)
    v_mfma_f32_32x32x16_bf16 v[32:47], v[72:75], v[136:139], v[32:47]
    ds_read_b64_tr_b16 v[92:93], v13 offset:47104
    ds_read_b64_tr_b16 v[94:95], v13 offset:47616
    ds_read_b128 v[156:159], v31 offset:512
    s_waitcnt lgkmcnt(12)
    v_mfma_f32_32x32x16_bf16 v[32:47], v[76:79], v[140:143], v[32:47]
    ds_read_b64_tr_b16 v[64:65], v13 offset:49152
    ds_read_b64_tr_b16 v[66:67], v13 offset:49664
    ds_read_b128 v[128:131], v24 offset:768
    s_waitcnt lgkmcnt(12)
    v_mfma_f32_32x32x16_bf16 v[32:47], v[80:83], v[144:147], v[32:47]
    ds_read_b64_tr_b16 v[68:69], v13 offset:51200
    ds_read_b64_tr_b16 v[70:71], v13 offset:51712
    ds_read_b128 v[132:135], v25 offset:768
    s_waitcnt lgkmcnt(12)
    v_mfma_f32_32x32x16_bf16 v[32:47], v[84:87], v[148:151], v[32:47]
    ds_read_b64_tr_b16 v[72:73], v13 offset:53248
    ds_read_b64_tr_b16 v[74:75], v13 offset:53760
    ds_read_b128 v[136:139], v26 offset:768
    s_waitcnt lgkmcnt(12)
    v_mfma_f32_32x32x16_bf16 v[32:47], v[88:91], v[152:155], v[32:47]
    ds_read_b64_tr_b16 v[76:77], v13 offset:55296
    ds_read_b64_tr_b16 v[78:79], v13 offset:55808
    ds_read_b128 v[140:143], v27 offset:768
    s_waitcnt lgkmcnt(12)
    v_mfma_f32_32x32x16_bf16 v[32:47], v[92:95], v[156:159], v[32:47]
    ds_read_b64_tr_b16 v[80:81], v13 offset:57344
    ds_read_b64_tr_b16 v[82:83], v13 offset:57856
    ds_read_b128 v[144:147], v28 offset:768
    s_waitcnt lgkmcnt(12)
    v_mfma_f32_32x32x16_bf16 v[32:47], v[64:67], v[128:131], v[32:47]
    ds_read_b64_tr_b16 v[84:85], v13 offset:59392
    ds_read_b64_tr_b16 v[86:87], v13 offset:59904
    ds_read_b128 v[148:151], v29 offset:768
    s_waitcnt lgkmcnt(12)
    v_mfma_f32_32x32x16_bf16 v[32:47], v[68:71], v[132:135], v[32:47]
    ds_read_b64_tr_b16 v[88:89], v13 offset:61440
    ds_read_b64_tr_b16 v[90:91], v13 offset:61952
    ds_read_b128 v[152:155], v30 offset:768
    s_waitcnt lgkmcnt(12)
    v_mfma_f32_32x32x16_bf16 v[32:47], v[72:75], v[136:139], v[32:47]
    ds_read_b64_tr_b16 v[92:93], v13 offset:63488
    ds_read_b64_tr_b16 v[94:95], v13 offset:64000
    ds_read_b128 v[156:159], v31 offset:768
    s_waitcnt lgkmcnt(12)
    v_mfma_f32_32x32x16_bf16 v[32:47], v[76:79], v[140:143], v[32:47]
    s_waitcnt lgkmcnt(9)
    v_mfma_f32_32x32x16_bf16 v[32:47], v[80:83], v[144:147], v[32:47]
    s_waitcnt lgkmcnt(6)
    v_mfma_f32_32x32x16_bf16 v[32:47], v[84:87], v[148:151], v[32:47]
    s_waitcnt lgkmcnt(3)
    v_mfma_f32_32x32x16_bf16 v[32:47], v[88:91], v[152:155], v[32:47]
    s_waitcnt lgkmcnt(0)
    v_mfma_f32_32x32x16_bf16 v[32:47], v[92:95], v[156:159], v[32:47]
    s_mov_b32 s3, 0x3eb8aa3b
    s_lshl_b32 s43, s42, 10
    v_add_u32 v8, s43, v2
    s_nop 11
    v_mul_f32 v32, s3, v32
    v_mul_f32 v33, s3, v33
    v_mul_f32 v34, s3, v34
    v_mul_f32 v35, s3, v35
    v_mul_f32 v36, s3, v36
    v_mul_f32 v37, s3, v37
    v_mul_f32 v38, s3, v38
    v_mul_f32 v39, s3, v39
    v_mul_f32 v40, s3, v40
    v_mul_f32 v41, s3, v41
    v_mul_f32 v42, s3, v42
    v_mul_f32 v43, s3, v43
    v_mul_f32 v44, s3, v44
    v_mul_f32 v45, s3, v45
    v_mul_f32 v46, s3, v46
    v_mul_f32 v47, s3, v47
    v_cvt_pk_bf16_f32 v12, v40, v41
    v_cvt_pk_bf16_f32 v13, v42, v43
    v_cvt_pk_bf16_f32 v14, v44, v45
    v_cvt_pk_bf16_f32 v15, v46, v47
    ds_write_b128 v8, v[12:15] offset:0
    v_cvt_pk_bf16_f32 v4, v32, v33
    v_cvt_pk_bf16_f32 v5, v34, v35
    v_cvt_pk_bf16_f32 v6, v36, v37
    v_cvt_pk_bf16_f32 v7, v38, v39
L_q_done:
    s_waitcnt lgkmcnt(0)
    s_barrier
    s_branch L_p1_end
L_p1_w7b:
    s_nop 3
    s_waitcnt vmcnt(0) lgkmcnt(0)
    s_barrier
    v_lshrrev_b32 v8, 4, v1
    v_and_b32 v9, 15, v1
    v_lshlrev_b32 v10, 8, v8
    v_lshl_add_u32 v10, v9, 3, v10
    v_xor_b32 v11, v8, v9
    v_lshlrev_b32 v11, 4, v11
    v_add_u32 v12, s47, v9
    v_lshlrev_b32 v12, 10, v12
    v_add_u32 v12, 32768, v12
    v_add_u32 v12, v12, v11
    v_xor_b32 v13, 64, v12
    v_xor_b32 v14, 0x80, v12
    v_xor_b32 v15, 0xc0, v12
    ds_read_b64_tr_b16 v[64:65], v10 offset:0
    ds_read_b64_tr_b16 v[66:67], v10 offset:128
    ds_read_b128 v[128:131], v12 offset:0
    ds_read_b64_tr_b16 v[68:69], v10 offset:1024
    ds_read_b64_tr_b16 v[70:71], v10 offset:1152
    ds_read_b128 v[132:135], v13 offset:0
    ds_read_b64_tr_b16 v[72:73], v10 offset:2048
    ds_read_b64_tr_b16 v[74:75], v10 offset:2176
    ds_read_b128 v[136:139], v14 offset:0
    ds_read_b64_tr_b16 v[76:77], v10 offset:3072
    ds_read_b64_tr_b16 v[78:79], v10 offset:3200
    ds_read_b128 v[140:143], v15 offset:0
    s_bitcmp1_b32 s40, 0
    s_cbranch_scc1 L_kv_v
    ds_read_b64_tr_b16 v[80:81], v10 offset:4096
    ds_read_b64_tr_b16 v[82:83], v10 offset:4224
    ds_read_b128 v[144:147], v12 offset:256
    s_waitcnt lgkmcnt(12)
    v_mfma_f32_16x16x32_bf16 v[16:19], v[64:67], v[128:131], 0
    ds_read_b64_tr_b16 v[84:85], v10 offset:5120
    ds_read_b64_tr_b16 v[86:87], v10 offset:5248
    ds_read_b128 v[148:151], v13 offset:256
    s_waitcnt lgkmcnt(12)
    v_mfma_f32_16x16x32_bf16 v[20:23], v[68:71], v[132:135], 0
    ds_read_b64_tr_b16 v[88:89], v10 offset:6144
    ds_read_b64_tr_b16 v[90:91], v10 offset:6272
    ds_read_b128 v[152:155], v14 offset:256
    s_waitcnt lgkmcnt(12)
    v_mfma_f32_16x16x32_bf16 v[16:19], v[72:75], v[136:139], v[16:19]
    ds_read_b64_tr_b16 v[92:93], v10 offset:7168
    ds_read_b64_tr_b16 v[94:95], v10 offset:7296
    ds_read_b128 v[156:159], v15 offset:256
    s_waitcnt lgkmcnt(12)
    v_mfma_f32_16x16x32_bf16 v[20:23], v[76:79], v[140:143], v[20:23]
    ds_read_b64_tr_b16 v[96:97], v10 offset:8192
    ds_read_b64_tr_b16 v[98:99], v10 offset:8320
    ds_read_b128 v[160:163], v12 offset:512
    s_waitcnt lgkmcnt(12)
    v_mfma_f32_16x16x32_bf16 v[16:19], v[80:83], v[144:147], v[16:19]
    ds_read_b64_tr_b16 v[100:101], v10 offset:9216
    ds_read_b64_tr_b16 v[102:103], v10 offset:9344
    ds_read_b128 v[164:167], v13 offset:512
    s_waitcnt lgkmcnt(12)
    v_mfma_f32_16x16x32_bf16 v[20:23], v[84:87], v[148:151], v[20:23]
    ds_read_b64_tr_b16 v[104:105], v10 offset:10240
    ds_read_b64_tr_b16 v[106:107], v10 offset:10368
    ds_read_b128 v[168:171], v14 offset:512
    s_waitcnt lgkmcnt(12)
    v_mfma_f32_16x16x32_bf16 v[16:19], v[88:91], v[152:155], v[16:19]
    ds_read_b64_tr_b16 v[108:109], v10 offset:11264
    ds_read_b64_tr_b16 v[110:111], v10 offset:11392
    ds_read_b128 v[172:175], v15 offset:512
    s_waitcnt lgkmcnt(12)
    v_mfma_f32_16x16x32_bf16 v[20:23], v[92:95], v[156:159], v[20:23]
    ds_read_b64_tr_b16 v[112:113], v10 offset:12288
    ds_read_b64_tr_b16 v[114:115], v10 offset:12416
    ds_read_b128 v[176:179], v12 offset:768
    s_waitcnt lgkmcnt(12)
    v_mfma_f32_16x16x32_bf16 v[16:19], v[96:99], v[160:163], v[16:19]
    ds_read_b64_tr_b16 v[116:117], v10 offset:13312
    ds_read_b64_tr_b16 v[118:119], v10 offset:13440
    ds_read_b128 v[180:183], v13 offset:768
    s_waitcnt lgkmcnt(12)
    v_mfma_f32_16x16x32_bf16 v[20:23], v[100:103], v[164:167], v[20:23]
    ds_read_b64_tr_b16 v[120:121], v10 offset:14336
    ds_read_b64_tr_b16 v[122:123], v10 offset:14464
    ds_read_b128 v[184:187], v14 offset:768
    s_waitcnt lgkmcnt(12)
    v_mfma_f32_16x16x32_bf16 v[16:19], v[104:107], v[168:171], v[16:19]
    ds_read_b64_tr_b16 v[124:125], v10 offset:15360
    ds_read_b64_tr_b16 v[126:127], v10 offset:15488
    ds_read_b128 v[188:191], v15 offset:768
    s_waitcnt lgkmcnt(12)
    v_mfma_f32_16x16x32_bf16 v[20:23], v[108:111], v[172:175], v[20:23]
    s_waitcnt lgkmcnt(9)
    v_mfma_f32_16x16x32_bf16 v[16:19], v[112:115], v[176:179], v[16:19]
    s_waitcnt lgkmcnt(6)
    v_mfma_f32_16x16x32_bf16 v[20:23], v[116:119], v[180:183], v[20:23]
    s_waitcnt lgkmcnt(3)
    v_mfma_f32_16x16x32_bf16 v[16:19], v[120:123], v[184:187], v[16:19]
    s_waitcnt lgkmcnt(0)
    v_mfma_f32_16x16x32_bf16 v[20:23], v[124:127], v[188:191], v[20:23]
    s_nop 7
    v_add_f32 v16, v16, v20
    v_add_f32 v17, v17, v21
    v_add_f32 v18, v18, v22
    v_add_f32 v19, v19, v23
    v_cvt_pk_bf16_f32 v16, v16, v17
    v_cvt_pk_bf16_f32 v17, v18, v19
    v_and_b32 v18, 1, v8
    v_lshlrev_b32 v18, 9, v18
    v_lshl_add_u32 v18, v9, 4, v18
    v_lshrrev_b32 v19, 1, v8
    v_lshl_add_u32 v18, v19, 3, v18
    s_lshl_b32 s3, s41, 1
    s_lshr_b32 s43, s47, 5
    s_add_u32 s3, s3, s43
    s_lshl_b32 s3, s3, 11
    s_and_b32 s43, s47, 16
    s_lshl_b32 s43, s43, 4
    s_add_u32 s3, s3, s43
    buffer_store_dwordx2 v[16:17], v18, s[36:39], s3 offen sc1
    v_dot2_f32_bf16 v20, v16, v16, 0
    v_dot2_f32_bf16 v20, v17, v17, v20
    s_nop 2
    v_mov_b32 v21, v20
    s_nop 1
    v_permlane32_swap_b32 v20, v21
    v_add_f32 v20, v20, v21
    v_mov_b32 v21, v20
    s_nop 1
    v_permlane16_swap_b32 v20, v21
    v_add_f32 v20, v20, v21
    s_nop 1
    v_max_f32_dpp v20, v20, v20 row_ror:8 row_mask:0xf bank_mask:0xf
    s_nop 1
    v_max_f32_dpp v20, v20, v20 row_ror:4 row_mask:0xf bank_mask:0xf
    s_nop 1
    v_max_f32_dpp v20, v20, v20 row_ror:2 row_mask:0xf bank_mask:0xf
    s_nop 1
    v_max_f32_dpp v20, v20, v20 row_ror:1 row_mask:0xf bank_mask:0xf
    s_lshl_b32 s3, s41, 2
    s_lshr_b32 s43, s40, 1
    s_add_u32 s3, s3, s43
    s_lshl_b32 s3, s3, 2
    s_add_u32 s3, s3, 0x20000
    s_mov_b64 exec, 1
    buffer_store_dword v20, off, s[36:39], s3 sc1
    s_mov_b64 exec, -1
    s_branch L_kv_done
L_kv_v:
    s_nop 3
    ds_read_b64_tr_b16 v[80:81], v10 offset:4096
    ds_read_b64_tr_b16 v[82:83], v10 offset:4224
    ds_read_b128 v[144:147], v12 offset:256
    s_waitcnt lgkmcnt(12)
    v_mfma_f32_16x16x32_bf16 v[16:19], v[128:131], v[64:67], 0
    ds_read_b64_tr_b16 v[84:85], v10 offset:5120
    ds_read_b64_tr_b16 v[86:87], v10 offset:5248
    ds_read_b128 v[148:151], v13 offset:256
    s_waitcnt lgkmcnt(12)
    v_mfma_f32_16x16x32_bf16 v[20:23], v[132:135], v[68:71], 0
    ds_read_b64_tr_b16 v[88:89], v10 offset:6144
    ds_read_b64_tr_b16 v[90:91], v10 offset:6272
    ds_read_b128 v[152:155], v14 offset:256
    s_waitcnt lgkmcnt(12)
    v_mfma_f32_16x16x32_bf16 v[16:19], v[136:139], v[72:75], v[16:19]
    ds_read_b64_tr_b16 v[92:93], v10 offset:7168
    ds_read_b64_tr_b16 v[94:95], v10 offset:7296
    ds_read_b128 v[156:159], v15 offset:256
    s_waitcnt lgkmcnt(12)
    v_mfma_f32_16x16x32_bf16 v[20:23], v[140:143], v[76:79], v[20:23]
    ds_read_b64_tr_b16 v[96:97], v10 offset:8192
    ds_read_b64_tr_b16 v[98:99], v10 offset:8320
    ds_read_b128 v[160:163], v12 offset:512
    s_waitcnt lgkmcnt(12)
    v_mfma_f32_16x16x32_bf16 v[16:19], v[144:147], v[80:83], v[16:19]
    ds_read_b64_tr_b16 v[100:101], v10 offset:9216
    ds_read_b64_tr_b16 v[102:103], v10 offset:9344
    ds_read_b128 v[164:167], v13 offset:512
    s_waitcnt lgkmcnt(12)
    v_mfma_f32_16x16x32_bf16 v[20:23], v[148:151], v[84:87], v[20:23]
    ds_read_b64_tr_b16 v[104:105], v10 offset:10240
    ds_read_b64_tr_b16 v[106:107], v10 offset:10368
    ds_read_b128 v[168:171], v14 offset:512
    s_waitcnt lgkmcnt(12)
    v_mfma_f32_16x16x32_bf16 v[16:19], v[152:155], v[88:91], v[16:19]
    ds_read_b64_tr_b16 v[108:109], v10 offset:11264
    ds_read_b64_tr_b16 v[110:111], v10 offset:11392
    ds_read_b128 v[172:175], v15 offset:512
    s_waitcnt lgkmcnt(12)
    v_mfma_f32_16x16x32_bf16 v[20:23], v[156:159], v[92:95], v[20:23]
    ds_read_b64_tr_b16 v[112:113], v10 offset:12288
    ds_read_b64_tr_b16 v[114:115], v10 offset:12416
    ds_read_b128 v[176:179], v12 offset:768
    s_waitcnt lgkmcnt(12)
    v_mfma_f32_16x16x32_bf16 v[16:19], v[160:163], v[96:99], v[16:19]
    ds_read_b64_tr_b16 v[116:117], v10 offset:13312
    ds_read_b64_tr_b16 v[118:119], v10 offset:13440
    ds_read_b128 v[180:183], v13 offset:768
    s_waitcnt lgkmcnt(12)
    v_mfma_f32_16x16x32_bf16 v[20:23], v[164:167], v[100:103], v[20:23]
    ds_read_b64_tr_b16 v[120:121], v10 offset:14336
    ds_read_b64_tr_b16 v[122:123], v10 offset:14464
    ds_read_b128 v[184:187], v14 offset:768
    s_waitcnt lgkmcnt(12)
    v_mfma_f32_16x16x32_bf16 v[16:19], v[168:171], v[104:107], v[16:19]
    ds_read_b64_tr_b16 v[124:125], v10 offset:15360
    ds_read_b64_tr_b16 v[126:127], v10 offset:15488
    ds_read_b128 v[188:191], v15 offset:768
    s_waitcnt lgkmcnt(12)
    v_mfma_f32_16x16x32_bf16 v[20:23], v[172:175], v[108:111], v[20:23]
    s_waitcnt lgkmcnt(9)
    v_mfma_f32_16x16x32_bf16 v[16:19], v[176:179], v[112:115], v[16:19]
    s_waitcnt lgkmcnt(6)
    v_mfma_f32_16x16x32_bf16 v[20:23], v[180:183], v[116:119], v[20:23]
    s_waitcnt lgkmcnt(3)
    v_mfma_f32_16x16x32_bf16 v[16:19], v[184:187], v[120:123], v[16:19]
    s_waitcnt lgkmcnt(0)
    v_mfma_f32_16x16x32_bf16 v[20:23], v[188:191], v[124:127], v[20:23]
    s_nop 7
    v_add_f32 v16, v16, v20
    v_add_f32 v17, v17, v21
    v_add_f32 v18, v18, v22
    v_add_f32 v19, v19, v23
    v_cvt_pk_bf16_f32 v16, v16, v17
    v_cvt_pk_bf16_f32 v17, v18, v19
    v_and_b32 v18, 1, v8
    v_lshlrev_b32 v18, 8, v18
    v_lshl_add_u32 v18, v9, 4, v18
    v_lshrrev_b32 v19, 1, v8
    v_lshl_add_u32 v18, v19, 3, v18
    s_lshl_b32 s3, s41, 1
    s_lshr_b32 s43, s47, 5
    s_add_u32 s3, s3, s43
    s_lshl_b32 s3, s3, 11
    s_and_b32 s43, s47, 16
    s_lshl_b32 s43, s43, 5
    s_add_u32 s43, s43, 1024
    s_add_u32 s3, s3, s43
    buffer_store_dwordx2 v[16:17], v18, s[36:39], s3 offen sc1
L_kv_done:
    s_nop 3
    s_lshl_b32 s3, s41, 3
    s_add_u32 s3, s3, s40
    s_lshl_b32 s3, s3, 2
    s_add_u32 s3, s3, 0x30000
    s_waitcnt vmcnt(0)
    v_mov_b32 v8, s17
    s_mov_b64 exec, 1
    buffer_store_dword v8, off, s[36:39], s3 sc1
    s_mov_b64 exec, -1
    s_barrier
    s_mov_b32 s43, 131072
    s_mov_b32 s3, 0x30000
L_poll_1:
    buffer_load_dwordx4 v[56:59], v2, s[36:39], s3 offen sc1
L_pc_3:
    s_waitcnt vmcnt(0)
    v_xor_b32 v56, s100, v56
    v_xor_b32 v57, s100, v57
    v_xor_b32 v58, s100, v58
    v_xor_b32 v59, s100, v59
    v_or3_b32 v56, v56, v57, v58
    v_or_b32 v56, v56, v59
    v_cmp_le_u32 vcc, 16, v56
    s_cbranch_vccz L_pd_2
    s_sub_u32 s43, s43, 1
    s_cmp_lg_u32 s43, 0
    s_sleep 2
    s_cbranch_scc1 L_poll_1
L_pd_2:
    v_and_b32 v8, 7, v1
    v_lshlrev_b32 v8, 2, v8
    s_lshl_b32 s3, s41, 5
    s_add_u32 s3, s3, 0x30000
    buffer_load_dword v12, v8, s[36:39], s3 offen sc1
    v_lshlrev_b32 v8, 3, v1
    s_mov_b32 s3, 0x20000
    buffer_load_dwordx2 v[10:11], v8, s[36:39], s3 offen sc1
    s_mov_b32 s3, 0
    s_mov_b32 s43, 16256
    s_mov_b32 m0, s43
    s_add_u32 s43, s43, 2064
    buffer_load_dwordx4 v2, s[36:39], s3 offen sc1 lds
    buffer_load_dwordx4 v2, s[36:39], s3 offen offset:1024 sc1 lds
    s_add_u32 s3, s3, 2048
    s_mov_b32 m0, s43
    s_add_u32 s43, s43, 2064
    buffer_load_dwordx4 v2, s[36:39], s3 offen sc1 lds
    buffer_load_dwordx4 v2, s[36:39], s3 offen offset:1024 sc1 lds
    s_add_u32 s3, s3, 2048
    s_mov_b32 m0, s43
    s_add_u32 s43, s43, 2064
    buffer_load_dwordx4 v2, s[36:39], s3 offen sc1 lds
    buffer_load_dwordx4 v2, s[36:39], s3 offen offset:1024 sc1 lds
    s_add_u32 s3, s3, 2048
    s_mov_b32 m0, s43
    s_add_u32 s43, s43, 2064
    buffer_load_dwordx4 v2, s[36:39], s3 offen sc1 lds
    buffer_load_dwordx4 v2, s[36:39], s3 offen offset:1024 sc1 lds
    s_add_u32 s3, s3, 2048
    s_mov_b32 m0, s43
    s_add_u32 s43, s43, 2064
    buffer_load_dwordx4 v2, s[36:39], s3 offen sc1 lds
    buffer_load_dwordx4 v2, s[36:39], s3 offen offset:1024 sc1 lds
    s_add_u32 s3, s3, 2048
    s_mov_b32 m0, s43
    s_add_u32 s43, s43, 2064
    buffer_load_dwordx4 v2, s[36:39], s3 offen sc1 lds
    buffer_load_dwordx4 v2, s[36:39], s3 offen offset:1024 sc1 lds
    s_add_u32 s3, s3, 2048
    s_mov_b32 m0, s43
    s_add_u32 s43, s43, 2064
    buffer_load_dwordx4 v2, s[36:39], s3 offen sc1 lds
    buffer_load_dwordx4 v2, s[36:39], s3 offen offset:1024 sc1 lds
    s_add_u32 s3, s3, 2048
    s_mov_b32 m0, s43
    s_add_u32 s43, s43, 2064
    buffer_load_dwordx4 v2, s[36:39], s3 offen sc1 lds
    buffer_load_dwordx4 v2, s[36:39], s3 offen offset:1024 sc1 lds
    s_waitcnt vmcnt(16)
    v_cmp_ne_u32 vcc, s17, v12
    s_nop 0
    s_cmp_eq_u64 vcc, 0
    s_cselect_b32 s3, 1, 0
    v_max_f32 v10, v10, v11
    v_mov_b32 v11, v10
    s_nop 1
    v_permlane32_swap_b32 v10, v11
    v_max_f32 v10, v10, v11
    v_mov_b32 v11, v10
    s_nop 1
    v_permlane16_swap_b32 v10, v11
    v_max_f32 v10, v10, v11
    s_nop 1
    v_max_f32_dpp v10, v10, v10 row_ror:8 row_mask:0xf bank_mask:0xf
    s_nop 1
    v_max_f32_dpp v10, v10, v10 row_ror:4 row_mask:0xf bank_mask:0xf
    s_nop 1
    v_max_f32_dpp v10, v10, v10 row_ror:2 row_mask:0xf bank_mask:0xf
    s_nop 1
    v_max_f32_dpp v10, v10, v10 row_ror:1 row_mask:0xf bank_mask:0xf
    v_mov_b32 v11, s3
    v_mov_b32 v12, 0
    v_mov_b32 v13, 0
    v_mov_b32 v8, 16128
    s_mov_b64 exec, 1
    ds_write_b128 v8, v[10:13]
    ds_write_b32 v8, v12 offset:16
    s_mov_b64 exec, -1
    s_waitcnt vmcnt(0) lgkmcnt(0)
    s_barrier
L_p1_end:
    s_nop 3
    s_and_b32 s48, s42, 1
    s_bfe_u32 s49, s42, 0x10001
    s_lshr_b32 s50, s42, 2
    v_mov_b32 v8, 16128
    ds_read_b64 v[10:11], v8
    s_cmp_eq_u32 s50, 0
    s_cbranch_scc1 L_q_have
    s_and_b32 s3, s42, 3
    s_lshl_b32 s3, s3, 10
    v_add_u32 v9, s3, v2
    ds_read_b128 v[4:7], v9 offset:0
L_q_have:
    s_nop 1
    v_mov_b32 v16, 0x3f803f80
    v_mov_b32 v17, v16
    v_mov_b32 v18, v16
    v_mov_b32 v19, v16
    s_movk_i32 s3, 2064
    v_mul_lo_u32 v20, v1, s3
    v_add_u32 v20, 18304, v20
    ds_write_b128 v20, v[16:19]
    v_lshrrev_b32 v8, 5, v1
    v_and_b32 v9, 15, v1
    v_lshl_add_u32 v8, v8, 4, v9
    v_lshlrev_b32 v8, 4, v8
    v_add_u32 v8, 17280, v8
    v_add_u32 v9, 512, v8
    v_and_b32 v13, 16, v1
    v_cmp_eq_u32 vcc, 0, v13
    v_mov_b32 v13, 18304
    s_nop 0
    v_cndmask_b32 v3, v13, v8, vcc
    v_cndmask_b32 v89, v13, v9, vcc
    v_add_u32 v88, 16256, v2
    v_and_b32 v13, 31, v1
    v_lshrrev_b32 v14, 5, v1
    v_lshlrev_b32 v13, 10, v13
    v_lshl_add_u32 v90, v14, 4, v13
    v_lshrrev_b32 v96, 3, v1
    v_and_b32 v97, 7, v1
    v_lshlrev_b32 v98, 1, v96
    v_and_b32 v98, 4, v98
    v_xor_b32 v97, v97, v98
    v_lshlrev_b32 v97, 4, v97
    v_mul_lo_u32 v99, v96, s56
    v_add_u32 v99, v99, v97
    v_bfe_u32 v21, v1, 4, 1
    v_bfe_u32 v22, v1, 2, 2
    v_and_b32 v23, 3, v1
    v_lshrrev_b32 v24, 1, v23
    v_lshl_add_u32 v24, v21, 1, v24
    v_lshrrev_b32 v25, 1, v22
    v_lshlrev_b32 v25, 2, v25
    v_xor_b32 v24, v24, v25
    v_lshlrev_b32 v24, 4, v24
    v_and_b32 v23, 1, v23
    v_lshl_add_u32 v24, v23, 3, v24
    v_lshl_add_u32 v25, v14, 2, v22
    v_lshl_add_u32 v25, v25, 7, v24
    v_add_u32 v100, s60, v25
    v_xor_b32 v101, 64, v100
    s_lshl_b32 s18, s42, 11
    s_add_u32 s18, s18, 16384
    s_mul_i32 s19, s42, 2064
    s_add_u32 s19, s19, 32768
    s_waitcnt lgkmcnt(1)
    v_readfirstlane_b32 s101, v11
    v_dot2_f32_bf16 v14, v4, v4, 0
    v_dot2_f32_bf16 v14, v5, v5, v14
    v_dot2_f32_bf16 v14, v6, v6, v14
    v_dot2_f32_bf16 v14, v7, v7, v14
    s_nop 2
    v_mov_b32 v13, v14
    s_nop 1
    v_permlane32_swap_b32 v14, v13
    v_add_f32 v14, v14, v13
    v_mul_f32 v14, v14, v10
    s_mov_b32 s3, 0x45610000
    v_cmp_nle_f32 vcc, v14, s3
    s_waitcnt lgkmcnt(0)
    s_cbranch_vccnz L_attn_fb
    s_setprio 3
    ds_read_b128 v[80:83], v88
    ds_read_b128 v[84:87], v88 offset:2064
    ds_read_b128 v[64:67], v3
    v_mov_b32 v40, 0
    v_mov_b32 v41, 0
    v_mov_b32 v42, 0
    v_mov_b32 v43, 0
    v_mov_b32 v44, 0
    v_mov_b32 v45, 0
    v_mov_b32 v46, 0
    v_mov_b32 v47, 0
    v_mov_b32 v48, 0
    v_mov_b32 v49, 0
    v_mov_b32 v50, 0
    v_mov_b32 v51, 0
    v_mov_b32 v52, 0
    v_mov_b32 v53, 0
    v_mov_b32 v54, 0
    v_mov_b32 v55, 0
    v_mov_b32 v60, 0
    v_mov_b32 v61, 0
    v_mov_b32 v62, 0
    v_mov_b32 v63, 0
    v_mov_b32 v76, 0
    v_mov_b32 v77, 0
    v_mov_b32 v78, 0
    v_mov_b32 v79, 0
    s_waitcnt lgkmcnt(2)
    v_mfma_f32_32x32x16_bf16 v[8:23], v[80:83], v[4:7], 0
    s_nop 11
    s_waitcnt lgkmcnt(0)
    v_mfma_f32_32x32x16_bf16 v[24:39], v[84:87], v[4:7], 0
    ds_read_b128 v[80:83], v88 offset:4128
    ds_read_b128 v[68:71], v3 offset:2064
    ds_read_b128 v[72:75], v89 offset:0
    v_exp_f32 v8, v8
    v_exp_f32 v9, v9
    s_mov_b32 m0, s19
    s_add_u32 s19, s19, 16512
    buffer_load_dwordx4 v2, s[36:39], s18 offen sc1 lds
    buffer_load_dwordx4 v2, s[36:39], s18 offen offset:1024 sc1 lds
    s_add_u32 s18, s18, 16384
    v_exp_f32 v10, v10
    v_exp_f32 v11, v11
    v_exp_f32 v12, v12
    v_exp_f32 v13, v13
    v_exp_f32 v14, v14
    v_exp_f32 v15, v15
    v_mfma_f32_32x32x16_bf16 v[40:55], v[76:79], v[60:63], v[40:55]
    v_cvt_pk_bf16_f32 v56, v8, v9
    v_cvt_pk_bf16_f32 v57, v10, v11
    v_cvt_pk_bf16_f32 v58, v12, v13
    v_cvt_pk_bf16_f32 v59, v14, v15
    v_exp_f32 v16, v16
    v_exp_f32 v17, v17
    v_exp_f32 v18, v18
    v_exp_f32 v19, v19
    v_mfma_f32_32x32x16_bf16 v[40:55], v[64:67], v[56:59], v[40:55]
    v_exp_f32 v20, v20
    v_exp_f32 v21, v21
    v_exp_f32 v22, v22
    v_exp_f32 v23, v23
    v_cvt_pk_bf16_f32 v60, v16, v17
    v_cvt_pk_bf16_f32 v61, v18, v19
    v_cvt_pk_bf16_f32 v62, v20, v21
    v_cvt_pk_bf16_f32 v63, v22, v23
    s_waitcnt lgkmcnt(0)
    v_mfma_f32_32x32x16_bf16 v[8:23], v[80:83], v[4:7], 0
    ds_read_b128 v[84:87], v88 offset:6192
    ds_read_b128 v[64:67], v3 offset:4128
    ds_read_b128 v[76:79], v89 offset:2064
    v_exp_f32 v24, v24
    v_exp_f32 v25, v25
    s_mov_b32 m0, s19
    s_add_u32 s19, s19, 16512
    buffer_load_dwordx4 v2, s[36:39], s18 offen sc1 lds
    buffer_load_dwordx4 v2, s[36:39], s18 offen offset:1024 sc1 lds
    s_add_u32 s18, s18, 16384
    v_exp_f32 v26, v26
    v_exp_f32 v27, v27
    v_exp_f32 v28, v28
    v_exp_f32 v29, v29
    v_exp_f32 v30, v30
    v_exp_f32 v31, v31
    v_mfma_f32_32x32x16_bf16 v[40:55], v[72:75], v[60:63], v[40:55]
    v_cvt_pk_bf16_f32 v56, v24, v25
    v_cvt_pk_bf16_f32 v57, v26, v27
    v_cvt_pk_bf16_f32 v58, v28, v29
    v_cvt_pk_bf16_f32 v59, v30, v31
    v_exp_f32 v32, v32
    v_exp_f32 v33, v33
    v_exp_f32 v34, v34
    v_exp_f32 v35, v35
    v_mfma_f32_32x32x16_bf16 v[40:55], v[68:71], v[56:59], v[40:55]
    v_exp_f32 v36, v36
    v_exp_f32 v37, v37
    v_exp_f32 v38, v38
    v_exp_f32 v39, v39
    v_cvt_pk_bf16_f32 v60, v32, v33
    v_cvt_pk_bf16_f32 v61, v34, v35
    v_cvt_pk_bf16_f32 v62, v36, v37
    v_cvt_pk_bf16_f32 v63, v38, v39
    s_waitcnt lgkmcnt(0)
    v_mfma_f32_32x32x16_bf16 v[24:39], v[84:87], v[4:7], 0
    ds_read_b128 v[80:83], v88 offset:8256
    ds_read_b128 v[68:71], v3 offset:6192
    ds_read_b128 v[72:75], v89 offset:4128
    v_exp_f32 v8, v8
    v_exp_f32 v9, v9
    s_mov_b32 m0, s60
    s_add_u32 s60, s60, 1024
    buffer_load_dwordx4 v99, s[52:55], s57 offen lds
    s_lshl_b32 s61, s56, 3
    s_add_u32 s57, s57, s61
    v_exp_f32 v10, v10
    v_exp_f32 v11, v11
    s_mov_b32 m0, s60
    s_add_u32 s60, s60, 1024
    buffer_load_dwordx4 v99, s[52:55], s57 offen lds
    v_exp_f32 v12, v12
    v_exp_f32 v13, v13
    v_exp_f32 v14, v14
    v_exp_f32 v15, v15
    v_mfma_f32_32x32x16_bf16 v[40:55], v[76:79], v[60:63], v[40:55]
    v_cvt_pk_bf16_f32 v56, v8, v9
    v_cvt_pk_bf16_f32 v57, v10, v11
    v_cvt_pk_bf16_f32 v58, v12, v13
    v_cvt_pk_bf16_f32 v59, v14, v15
    v_exp_f32 v16, v16
    v_exp_f32 v17, v17
    v_exp_f32 v18, v18
    v_exp_f32 v19, v19
    v_mfma_f32_32x32x16_bf16 v[40:55], v[64:67], v[56:59], v[40:55]
    v_exp_f32 v20, v20
    v_exp_f32 v21, v21
    v_exp_f32 v22, v22
    v_exp_f32 v23, v23
    v_cvt_pk_bf16_f32 v60, v16, v17
    v_cvt_pk_bf16_f32 v61, v18, v19
    v_cvt_pk_bf16_f32 v62, v20, v21
    v_cvt_pk_bf16_f32 v63, v22, v23
    s_waitcnt lgkmcnt(0)
    v_mfma_f32_32x32x16_bf16 v[8:23], v[80:83], v[4:7], 0
    ds_read_b128 v[84:87], v88 offset:10320
    ds_read_b128 v[64:67], v3 offset:8256
    ds_read_b128 v[76:79], v89 offset:6192
    v_exp_f32 v24, v24
    v_exp_f32 v25, v25
    s_mov_b32 m0, s19
    s_add_u32 s19, s19, 16512
    buffer_load_dwordx4 v2, s[36:39], s18 offen sc1 lds
    buffer_load_dwordx4 v2, s[36:39], s18 offen offset:1024 sc1 lds
    s_add_u32 s18, s18, 16384
    v_exp_f32 v26, v26
    v_exp_f32 v27, v27
    v_exp_f32 v28, v28
    v_exp_f32 v29, v29
    v_exp_f32 v30, v30
    v_exp_f32 v31, v31
    v_mfma_f32_32x32x16_bf16 v[40:55], v[72:75], v[60:63], v[40:55]
    v_cvt_pk_bf16_f32 v56, v24, v25
    v_cvt_pk_bf16_f32 v57, v26, v27
    v_cvt_pk_bf16_f32 v58, v28, v29
    v_cvt_pk_bf16_f32 v59, v30, v31
    v_exp_f32 v32, v32
    v_exp_f32 v33, v33
    v_exp_f32 v34, v34
    v_exp_f32 v35, v35
    v_mfma_f32_32x32x16_bf16 v[40:55], v[68:71], v[56:59], v[40:55]
    v_exp_f32 v36, v36
    v_exp_f32 v37, v37
    v_exp_f32 v38, v38
    v_exp_f32 v39, v39
    v_cvt_pk_bf16_f32 v60, v32, v33
    v_cvt_pk_bf16_f32 v61, v34, v35
    v_cvt_pk_bf16_f32 v62, v36, v37
    v_cvt_pk_bf16_f32 v63, v38, v39
    s_waitcnt lgkmcnt(0)
    v_mfma_f32_32x32x16_bf16 v[24:39], v[84:87], v[4:7], 0
    ds_read_b128 v[80:83], v88 offset:12384
    ds_read_b128 v[68:71], v3 offset:10320
    ds_read_b128 v[72:75], v89 offset:8256
    v_exp_f32 v8, v8
    v_exp_f32 v9, v9
    s_mov_b32 m0, s19
    s_add_u32 s19, s19, 16512
    buffer_load_dwordx4 v2, s[36:39], s18 offen sc1 lds
    buffer_load_dwordx4 v2, s[36:39], s18 offen offset:1024 sc1 lds
    s_add_u32 s18, s18, 16384
    v_exp_f32 v10, v10
    v_exp_f32 v11, v11
    v_exp_f32 v12, v12
    v_exp_f32 v13, v13
    v_exp_f32 v14, v14
    v_exp_f32 v15, v15
    v_mfma_f32_32x32x16_bf16 v[40:55], v[76:79], v[60:63], v[40:55]
    v_cvt_pk_bf16_f32 v56, v8, v9
    v_cvt_pk_bf16_f32 v57, v10, v11
    v_cvt_pk_bf16_f32 v58, v12, v13
    v_cvt_pk_bf16_f32 v59, v14, v15
    v_exp_f32 v16, v16
    v_exp_f32 v17, v17
    v_exp_f32 v18, v18
    v_exp_f32 v19, v19
    v_mfma_f32_32x32x16_bf16 v[40:55], v[64:67], v[56:59], v[40:55]
    v_exp_f32 v20, v20
    v_exp_f32 v21, v21
    v_exp_f32 v22, v22
    v_exp_f32 v23, v23
    v_cvt_pk_bf16_f32 v60, v16, v17
    v_cvt_pk_bf16_f32 v61, v18, v19
    v_cvt_pk_bf16_f32 v62, v20, v21
    v_cvt_pk_bf16_f32 v63, v22, v23
    s_waitcnt lgkmcnt(0)
    v_mfma_f32_32x32x16_bf16 v[8:23], v[80:83], v[4:7], 0
    ds_read_b128 v[84:87], v88 offset:14448
    ds_read_b128 v[64:67], v3 offset:12384
    ds_read_b128 v[76:79], v89 offset:10320
    v_exp_f32 v24, v24
    v_exp_f32 v25, v25
    s_mov_b32 m0, s19
    s_add_u32 s19, s19, 16512
    buffer_load_dwordx4 v2, s[36:39], s18 offen sc1 lds
    buffer_load_dwordx4 v2, s[36:39], s18 offen offset:1024 sc1 lds
    s_add_u32 s18, s18, 16384
    v_exp_f32 v26, v26
    v_exp_f32 v27, v27
    v_exp_f32 v28, v28
    v_exp_f32 v29, v29
    v_exp_f32 v30, v30
    v_exp_f32 v31, v31
    v_mfma_f32_32x32x16_bf16 v[40:55], v[72:75], v[60:63], v[40:55]
    v_cvt_pk_bf16_f32 v56, v24, v25
    v_cvt_pk_bf16_f32 v57, v26, v27
    v_cvt_pk_bf16_f32 v58, v28, v29
    v_cvt_pk_bf16_f32 v59, v30, v31
    v_exp_f32 v32, v32
    v_exp_f32 v33, v33
    v_exp_f32 v34, v34
    v_exp_f32 v35, v35
    v_mfma_f32_32x32x16_bf16 v[40:55], v[68:71], v[56:59], v[40:55]
    v_exp_f32 v36, v36
    v_exp_f32 v37, v37
    v_exp_f32 v38, v38
    v_exp_f32 v39, v39
    v_cvt_pk_bf16_f32 v60, v32, v33
    v_cvt_pk_bf16_f32 v61, v34, v35
    v_cvt_pk_bf16_f32 v62, v36, v37
    v_cvt_pk_bf16_f32 v63, v38, v39
    s_waitcnt vmcnt(10)
    s_barrier
    s_waitcnt lgkmcnt(0)
    v_mfma_f32_32x32x16_bf16 v[24:39], v[84:87], v[4:7], 0
    ds_read_b128 v[80:83], v88 offset:16512
    ds_read_b128 v[68:71], v3 offset:14448
    ds_read_b128 v[72:75], v89 offset:12384
    v_exp_f32 v8, v8
    v_exp_f32 v9, v9
    s_mov_b32 m0, s19
    s_add_u32 s19, s19, 16512
    buffer_load_dwordx4 v2, s[36:39], s18 offen sc1 lds
    buffer_load_dwordx4 v2, s[36:39], s18 offen offset:1024 sc1 lds
    s_add_u32 s18, s18, 16384
    v_exp_f32 v10, v10
    v_exp_f32 v11, v11
    v_exp_f32 v12, v12
    v_exp_f32 v13, v13
    v_exp_f32 v14, v14
    v_exp_f32 v15, v15
    v_mfma_f32_32x32x16_bf16 v[40:55], v[76:79], v[60:63], v[40:55]
    v_cvt_pk_bf16_f32 v56, v8, v9
    v_cvt_pk_bf16_f32 v57, v10, v11
    v_cvt_pk_bf16_f32 v58, v12, v13
    v_cvt_pk_bf16_f32 v59, v14, v15
    v_exp_f32 v16, v16
    v_exp_f32 v17, v17
    v_exp_f32 v18, v18
    v_exp_f32 v19, v19
    v_mfma_f32_32x32x16_bf16 v[40:55], v[64:67], v[56:59], v[40:55]
    v_exp_f32 v20, v20
    v_exp_f32 v21, v21
    v_exp_f32 v22, v22
    v_exp_f32 v23, v23
    v_cvt_pk_bf16_f32 v60, v16, v17
    v_cvt_pk_bf16_f32 v61, v18, v19
    v_cvt_pk_bf16_f32 v62, v20, v21
    v_cvt_pk_bf16_f32 v63, v22, v23
    s_waitcnt lgkmcnt(0)
    v_mfma_f32_32x32x16_bf16 v[8:23], v[80:83], v[4:7], 0
    ds_read_b128 v[84:87], v88 offset:18576
    ds_read_b128 v[64:67], v3 offset:16512
    ds_read_b128 v[76:79], v89 offset:14448
    v_exp_f32 v24, v24
    v_exp_f32 v25, v25
    s_mov_b32 m0, s19
    s_add_u32 s19, s19, 16512
    buffer_load_dwordx4 v2, s[36:39], s18 offen sc1 lds
    buffer_load_dwordx4 v2, s[36:39], s18 offen offset:1024 sc1 lds
    s_add_u32 s18, s18, 16384
    v_exp_f32 v26, v26
    v_exp_f32 v27, v27
    v_exp_f32 v28, v28
    v_exp_f32 v29, v29
    v_exp_f32 v30, v30
    v_exp_f32 v31, v31
    v_mfma_f32_32x32x16_bf16 v[40:55], v[72:75], v[60:63], v[40:55]
    v_cvt_pk_bf16_f32 v56, v24, v25
    v_cvt_pk_bf16_f32 v57, v26, v27
    v_cvt_pk_bf16_f32 v58, v28, v29
    v_cvt_pk_bf16_f32 v59, v30, v31
    v_exp_f32 v32, v32
    v_exp_f32 v33, v33
    v_exp_f32 v34, v34
    v_exp_f32 v35, v35
    v_mfma_f32_32x32x16_bf16 v[40:55], v[68:71], v[56:59], v[40:55]
    v_exp_f32 v36, v36
    v_exp_f32 v37, v37
    v_exp_f32 v38, v38
    v_exp_f32 v39, v39
    v_cvt_pk_bf16_f32 v60, v32, v33
    v_cvt_pk_bf16_f32 v61, v34, v35
    v_cvt_pk_bf16_f32 v62, v36, v37
    v_cvt_pk_bf16_f32 v63, v38, v39
    v_add_u32 v88, 0x4080, v88
    v_add_u32 v3, 0x4080, v3
    v_add_u32 v89, 0x4080, v89
    s_waitcnt lgkmcnt(0)
    v_mfma_f32_32x32x16_bf16 v[24:39], v[84:87], v[4:7], 0
    ds_read_b128 v[80:83], v88 offset:4128
    ds_read_b128 v[68:71], v3 offset:2064
    ds_read_b128 v[72:75], v89 offset:0
    v_exp_f32 v8, v8
    v_exp_f32 v9, v9
    s_waitcnt vmcnt(10)
    v_exp_f32 v10, v10
    v_exp_f32 v11, v11
    ds_read_b64_tr_b16 v[104:105], v100
    ds_read_b64_tr_b16 v[106:107], v100 offset:1024
    v_exp_f32 v12, v12
    v_exp_f32 v13, v13
    ds_read_b64_tr_b16 v[108:109], v101
    ds_read_b64_tr_b16 v[110:111], v101 offset:1024
    v_exp_f32 v14, v14
    v_exp_f32 v15, v15
    v_mfma_f32_32x32x16_bf16 v[40:55], v[76:79], v[60:63], v[40:55]
    v_cvt_pk_bf16_f32 v56, v8, v9
    v_cvt_pk_bf16_f32 v57, v10, v11
    v_cvt_pk_bf16_f32 v58, v12, v13
    v_cvt_pk_bf16_f32 v59, v14, v15
    v_exp_f32 v16, v16
    v_exp_f32 v17, v17
    v_exp_f32 v18, v18
    v_exp_f32 v19, v19
    v_mfma_f32_32x32x16_bf16 v[40:55], v[64:67], v[56:59], v[40:55]
    v_exp_f32 v20, v20
    v_exp_f32 v21, v21
    v_exp_f32 v22, v22
    v_exp_f32 v23, v23
    v_cvt_pk_bf16_f32 v60, v16, v17
    v_cvt_pk_bf16_f32 v61, v18, v19
    v_cvt_pk_bf16_f32 v62, v20, v21
    v_cvt_pk_bf16_f32 v63, v22, v23
    s_waitcnt lgkmcnt(0)
    v_mfma_f32_32x32x16_bf16 v[8:23], v[80:83], v[4:7], 0
    ds_read_b128 v[84:87], v88 offset:6192
    ds_read_b128 v[64:67], v3 offset:4128
    ds_read_b128 v[76:79], v89 offset:2064
    v_exp_f32 v24, v24
    v_exp_f32 v25, v25
    buffer_store_dwordx4 v[104:107], v2, s[36:39], s58 offen sc1
    s_add_u32 s58, s58, s59
    v_exp_f32 v26, v26
    v_exp_f32 v27, v27
    buffer_store_dwordx4 v[108:111], v2, s[36:39], s58 offen sc1
    v_exp_f32 v28, v28
    v_exp_f32 v29, v29
    v_exp_f32 v30, v30
    v_exp_f32 v31, v31
    v_mfma_f32_32x32x16_bf16 v[40:55], v[72:75], v[60:63], v[40:55]
    v_cvt_pk_bf16_f32 v56, v24, v25
    v_cvt_pk_bf16_f32 v57, v26, v27
    v_cvt_pk_bf16_f32 v58, v28, v29
    v_cvt_pk_bf16_f32 v59, v30, v31
    v_exp_f32 v32, v32
    v_exp_f32 v33, v33
    v_exp_f32 v34, v34
    v_exp_f32 v35, v35
    v_mfma_f32_32x32x16_bf16 v[40:55], v[68:71], v[56:59], v[40:55]
    v_exp_f32 v36, v36
    v_exp_f32 v37, v37
    v_exp_f32 v38, v38
    v_exp_f32 v39, v39
    v_cvt_pk_bf16_f32 v60, v32, v33
    v_cvt_pk_bf16_f32 v61, v34, v35
    v_cvt_pk_bf16_f32 v62, v36, v37
    v_cvt_pk_bf16_f32 v63, v38, v39
    s_waitcnt lgkmcnt(0)
    v_mfma_f32_32x32x16_bf16 v[24:39], v[84:87], v[4:7], 0
    ds_read_b128 v[80:83], v88 offset:8256
    ds_read_b128 v[68:71], v3 offset:6192
    ds_read_b128 v[72:75], v89 offset:4128
    v_exp_f32 v8, v8
    v_exp_f32 v9, v9
    v_exp_f32 v10, v10
    v_exp_f32 v11, v11
    v_exp_f32 v12, v12
    v_exp_f32 v13, v13
    v_exp_f32 v14, v14
    v_exp_f32 v15, v15
    v_mfma_f32_32x32x16_bf16 v[40:55], v[76:79], v[60:63], v[40:55]
    v_cvt_pk_bf16_f32 v56, v8, v9
    v_cvt_pk_bf16_f32 v57, v10, v11
    v_cvt_pk_bf16_f32 v58, v12, v13
    v_cvt_pk_bf16_f32 v59, v14, v15
    v_exp_f32 v16, v16
    v_exp_f32 v17, v17
    v_exp_f32 v18, v18
    v_exp_f32 v19, v19
    v_mfma_f32_32x32x16_bf16 v[40:55], v[64:67], v[56:59], v[40:55]
    v_exp_f32 v20, v20
    v_exp_f32 v21, v21
    v_exp_f32 v22, v22
    v_exp_f32 v23, v23
    v_cvt_pk_bf16_f32 v60, v16, v17
    v_cvt_pk_bf16_f32 v61, v18, v19
    v_cvt_pk_bf16_f32 v62, v20, v21
    v_cvt_pk_bf16_f32 v63, v22, v23
    s_waitcnt lgkmcnt(0)
    v_mfma_f32_32x32x16_bf16 v[8:23], v[80:83], v[4:7], 0
    ds_read_b128 v[84:87], v88 offset:10320
    ds_read_b128 v[64:67], v3 offset:8256
    ds_read_b128 v[76:79], v89 offset:6192
    v_exp_f32 v24, v24
    v_exp_f32 v25, v25
    v_exp_f32 v26, v26
    v_exp_f32 v27, v27
    v_exp_f32 v28, v28
    v_exp_f32 v29, v29
    v_exp_f32 v30, v30
    v_exp_f32 v31, v31
    v_mfma_f32_32x32x16_bf16 v[40:55], v[72:75], v[60:63], v[40:55]
    v_cvt_pk_bf16_f32 v56, v24, v25
    v_cvt_pk_bf16_f32 v57, v26, v27
    v_cvt_pk_bf16_f32 v58, v28, v29
    v_cvt_pk_bf16_f32 v59, v30, v31
    v_exp_f32 v32, v32
    v_exp_f32 v33, v33
    v_exp_f32 v34, v34
    v_exp_f32 v35, v35
    v_mfma_f32_32x32x16_bf16 v[40:55], v[68:71], v[56:59], v[40:55]
    v_exp_f32 v36, v36
    v_exp_f32 v37, v37
    v_exp_f32 v38, v38
    v_exp_f32 v39, v39
    v_cvt_pk_bf16_f32 v60, v32, v33
    v_cvt_pk_bf16_f32 v61, v34, v35
    v_cvt_pk_bf16_f32 v62, v36, v37
    v_cvt_pk_bf16_f32 v63, v38, v39
    s_waitcnt lgkmcnt(0)
    v_mfma_f32_32x32x16_bf16 v[24:39], v[84:87], v[4:7], 0
    ds_read_b128 v[80:83], v88 offset:12384
    ds_read_b128 v[68:71], v3 offset:10320
    ds_read_b128 v[72:75], v89 offset:8256
    v_exp_f32 v8, v8
    v_exp_f32 v9, v9
    v_exp_f32 v10, v10
    v_exp_f32 v11, v11
    v_exp_f32 v12, v12
    v_exp_f32 v13, v13
    v_exp_f32 v14, v14
    v_exp_f32 v15, v15
    v_mfma_f32_32x32x16_bf16 v[40:55], v[76:79], v[60:63], v[40:55]
    v_cvt_pk_bf16_f32 v56, v8, v9
    v_cvt_pk_bf16_f32 v57, v10, v11
    v_cvt_pk_bf16_f32 v58, v12, v13
    v_cvt_pk_bf16_f32 v59, v14, v15
    v_exp_f32 v16, v16
    v_exp_f32 v17, v17
    v_exp_f32 v18, v18
    v_exp_f32 v19, v19
    v_mfma_f32_32x32x16_bf16 v[40:55], v[64:67], v[56:59], v[40:55]
    v_exp_f32 v20, v20
    v_exp_f32 v21, v21
    v_exp_f32 v22, v22
    v_exp_f32 v23, v23
    v_cvt_pk_bf16_f32 v60, v16, v17
    v_cvt_pk_bf16_f32 v61, v18, v19
    v_cvt_pk_bf16_f32 v62, v20, v21
    v_cvt_pk_bf16_f32 v63, v22, v23
    s_waitcnt lgkmcnt(0)
    v_mfma_f32_32x32x16_bf16 v[8:23], v[80:83], v[4:7], 0
    ds_read_b128 v[84:87], v88 offset:14448
    ds_read_b128 v[64:67], v3 offset:12384
    ds_read_b128 v[76:79], v89 offset:10320
    v_exp_f32 v24, v24
    v_exp_f32 v25, v25
    v_exp_f32 v26, v26
    v_exp_f32 v27, v27
    v_exp_f32 v28, v28
    v_exp_f32 v29, v29
    v_exp_f32 v30, v30
    v_exp_f32 v31, v31
    v_mfma_f32_32x32x16_bf16 v[40:55], v[72:75], v[60:63], v[40:55]
    v_cvt_pk_bf16_f32 v56, v24, v25
    v_cvt_pk_bf16_f32 v57, v26, v27
    v_cvt_pk_bf16_f32 v58, v28, v29
    v_cvt_pk_bf16_f32 v59, v30, v31
    v_exp_f32 v32, v32
    v_exp_f32 v33, v33
    v_exp_f32 v34, v34
    v_exp_f32 v35, v35
    v_mfma_f32_32x32x16_bf16 v[40:55], v[68:71], v[56:59], v[40:55]
    v_exp_f32 v36, v36
    v_exp_f32 v37, v37
    v_exp_f32 v38, v38
    v_exp_f32 v39, v39
    v_cvt_pk_bf16_f32 v60, v32, v33
    v_cvt_pk_bf16_f32 v61, v34, v35
    v_cvt_pk_bf16_f32 v62, v36, v37
    v_cvt_pk_bf16_f32 v63, v38, v39
    s_waitcnt vmcnt(0)
    s_barrier
    s_cmp_lg_u32 s42, 7
    s_cbranch_scc1 L_f2_4
    s_lshl_b32 s18, s2, 2
    s_add_u32 s18, s18, 0x30400
    v_mov_b32 v96, s100
    s_mov_b64 exec, 1
    buffer_store_dword v96, off, s[36:39], s18 sc1
    s_mov_b64 exec, -1
L_f2_4:
    s_waitcnt lgkmcnt(0)
    v_mfma_f32_32x32x16_bf16 v[24:39], v[84:87], v[4:7], 0
    ds_read_b128 v[80:83], v88 offset:16512
    ds_read_b128 v[68:71], v3 offset:14448
    ds_read_b128 v[72:75], v89 offset:12384
    v_exp_f32 v8, v8
    v_exp_f32 v9, v9
    v_exp_f32 v10, v10
    v_exp_f32 v11, v11
    v_exp_f32 v12, v12
    v_exp_f32 v13, v13
    v_exp_f32 v14, v14
    v_exp_f32 v15, v15
    v_mfma_f32_32x32x16_bf16 v[40:55], v[76:79], v[60:63], v[40:55]
    v_cvt_pk_bf16_f32 v56, v8, v9
    v_cvt_pk_bf16_f32 v57, v10, v11
    v_cvt_pk_bf16_f32 v58, v12, v13
    v_cvt_pk_bf16_f32 v59, v14, v15
    v_exp_f32 v16, v16
    v_exp_f32 v17, v17
    v_exp_f32 v18, v18
    v_exp_f32 v19, v19
    v_mfma_f32_32x32x16_bf16 v[40:55], v[64:67], v[56:59], v[40:55]
    v_exp_f32 v20, v20
    v_exp_f32 v21, v21
    v_exp_f32 v22, v22
    v_exp_f32 v23, v23
    v_cvt_pk_bf16_f32 v60, v16, v17
    v_cvt_pk_bf16_f32 v61, v18, v19
    v_cvt_pk_bf16_f32 v62, v20, v21
    v_cvt_pk_bf16_f32 v63, v22, v23
    s_waitcnt lgkmcnt(0)
    v_mfma_f32_32x32x16_bf16 v[8:23], v[80:83], v[4:7], 0
    ds_read_b128 v[84:87], v88 offset:18576
    ds_read_b128 v[64:67], v3 offset:16512
    ds_read_b128 v[76:79], v89 offset:14448
    v_exp_f32 v24, v24
    v_exp_f32 v25, v25
    v_exp_f32 v26, v26
    v_exp_f32 v27, v27
    v_exp_f32 v28, v28
    v_exp_f32 v29, v29
    v_exp_f32 v30, v30
    v_exp_f32 v31, v31
    v_mfma_f32_32x32x16_bf16 v[40:55], v[72:75], v[60:63], v[40:55]
    v_cvt_pk_bf16_f32 v56, v24, v25
    v_cvt_pk_bf16_f32 v57, v26, v27
    v_cvt_pk_bf16_f32 v58, v28, v29
    v_cvt_pk_bf16_f32 v59, v30, v31
    v_exp_f32 v32, v32
    v_exp_f32 v33, v33
    v_exp_f32 v34, v34
    v_exp_f32 v35, v35
    v_mfma_f32_32x32x16_bf16 v[40:55], v[68:71], v[56:59], v[40:55]
    v_exp_f32 v36, v36
    v_exp_f32 v37, v37
    v_exp_f32 v38, v38
    v_exp_f32 v39, v39
    v_cvt_pk_bf16_f32 v60, v32, v33
    v_cvt_pk_bf16_f32 v61, v34, v35
    v_cvt_pk_bf16_f32 v62, v36, v37
    v_cvt_pk_bf16_f32 v63, v38, v39
    v_add_u32 v88, 0x4080, v88
    v_add_u32 v3, 0x4080, v3
    v_add_u32 v89, 0x4080, v89
    s_mov_b32 s62, 6
    s_lshr_b32 s63, s42, 2
    s_mov_b32 s3, 0x30400
.p2align 6
L_attn_a:
    s_setprio 3
    s_cmp_ge_u32 s62, 5
    s_cbranch_scc1 L_fp_5
    s_setprio 2
    s_cmp_ge_u32 s62, 3
    s_cbranch_scc1 L_fp_5
    s_setprio 1
    s_cmp_ge_u32 s62, 2
    s_cbranch_scc1 L_fp_5
    s_setprio 0
L_fp_5:
    s_waitcnt lgkmcnt(0)
    v_mfma_f32_32x32x16_bf16 v[24:39], v[84:87], v[4:7], 0
    ds_read_b128 v[80:83], v88 offset:4128
    ds_read_b128 v[68:71], v3 offset:2064
    ds_read_b128 v[72:75], v89 offset:0
    v_exp_f32 v8, v8
    v_exp_f32 v9, v9
    v_exp_f32 v10, v10
    v_exp_f32 v11, v11
    v_exp_f32 v12, v12
    v_exp_f32 v13, v13
    v_exp_f32 v14, v14
    v_exp_f32 v15, v15
    v_mfma_f32_32x32x16_bf16 v[40:55], v[76:79], v[60:63], v[40:55]
    v_cvt_pk_bf16_f32 v56, v8, v9
    v_cvt_pk_bf16_f32 v57, v10, v11
    v_cvt_pk_bf16_f32 v58, v12, v13
    v_cvt_pk_bf16_f32 v59, v14, v15
    v_exp_f32 v16, v16
    v_exp_f32 v17, v17
    v_exp_f32 v18, v18
    v_exp_f32 v19, v19
    v_mfma_f32_32x32x16_bf16 v[40:55], v[64:67], v[56:59], v[40:55]
    v_exp_f32 v20, v20
    v_exp_f32 v21, v21
    v_exp_f32 v22, v22
    v_exp_f32 v23, v23
    v_cvt_pk_bf16_f32 v60, v16, v17
    v_cvt_pk_bf16_f32 v61, v18, v19
    v_cvt_pk_bf16_f32 v62, v20, v21
    v_cvt_pk_bf16_f32 v63, v22, v23
    s_waitcnt lgkmcnt(0)
    v_mfma_f32_32x32x16_bf16 v[8:23], v[80:83], v[4:7], 0
    ds_read_b128 v[84:87], v88 offset:6192
    ds_read_b128 v[64:67], v3 offset:4128
    ds_read_b128 v[76:79], v89 offset:2064
    v_exp_f32 v24, v24
    v_exp_f32 v25, v25
    v_exp_f32 v26, v26
    v_exp_f32 v27, v27
    v_exp_f32 v28, v28
    v_exp_f32 v29, v29
    v_exp_f32 v30, v30
    v_exp_f32 v31, v31
    v_mfma_f32_32x32x16_bf16 v[40:55], v[72:75], v[60:63], v[40:55]
    v_cvt_pk_bf16_f32 v56, v24, v25
    v_cvt_pk_bf16_f32 v57, v26, v27
    v_cvt_pk_bf16_f32 v58, v28, v29
    v_cvt_pk_bf16_f32 v59, v30, v31
    v_exp_f32 v32, v32
    v_exp_f32 v33, v33
    v_exp_f32 v34, v34
    v_exp_f32 v35, v35
    v_mfma_f32_32x32x16_bf16 v[40:55], v[68:71], v[56:59], v[40:55]
    v_exp_f32 v36, v36
    v_exp_f32 v37, v37
    v_exp_f32 v38, v38
    v_exp_f32 v39, v39
    v_cvt_pk_bf16_f32 v60, v32, v33
    v_cvt_pk_bf16_f32 v61, v34, v35
    v_cvt_pk_bf16_f32 v62, v36, v37
    v_cvt_pk_bf16_f32 v63, v38, v39
    s_waitcnt lgkmcnt(0)
    v_mfma_f32_32x32x16_bf16 v[24:39], v[84:87], v[4:7], 0
    ds_read_b128 v[80:83], v88 offset:8256
    ds_read_b128 v[68:71], v3 offset:6192
    ds_read_b128 v[72:75], v89 offset:4128
    v_exp_f32 v8, v8
    v_exp_f32 v9, v9
    v_exp_f32 v10, v10
    v_exp_f32 v11, v11
    v_exp_f32 v12, v12
    v_exp_f32 v13, v13
    v_exp_f32 v14, v14
    v_exp_f32 v15, v15
    v_mfma_f32_32x32x16_bf16 v[40:55], v[76:79], v[60:63], v[40:55]
    v_cvt_pk_bf16_f32 v56, v8, v9
    v_cvt_pk_bf16_f32 v57, v10, v11
    v_cvt_pk_bf16_f32 v58, v12, v13
    v_cvt_pk_bf16_f32 v59, v14, v15
    v_exp_f32 v16, v16
    v_exp_f32 v17, v17
    v_exp_f32 v18, v18
    v_exp_f32 v19, v19
    v_mfma_f32_32x32x16_bf16 v[40:55], v[64:67], v[56:59], v[40:55]
    v_exp_f32 v20, v20
    v_exp_f32 v21, v21
    v_exp_f32 v22, v22
    v_exp_f32 v23, v23
    v_cvt_pk_bf16_f32 v60, v16, v17
    v_cvt_pk_bf16_f32 v61, v18, v19
    v_cvt_pk_bf16_f32 v62, v20, v21
    v_cvt_pk_bf16_f32 v63, v22, v23
    s_waitcnt lgkmcnt(0)
    v_mfma_f32_32x32x16_bf16 v[8:23], v[80:83], v[4:7], 0
    ds_read_b128 v[84:87], v88 offset:10320
    ds_read_b128 v[64:67], v3 offset:8256
    ds_read_b128 v[76:79], v89 offset:6192
    v_exp_f32 v24, v24
    v_exp_f32 v25, v25
    v_exp_f32 v26, v26
    v_exp_f32 v27, v27
    v_exp_f32 v28, v28
    v_exp_f32 v29, v29
    v_exp_f32 v30, v30
    v_exp_f32 v31, v31
    v_mfma_f32_32x32x16_bf16 v[40:55], v[72:75], v[60:63], v[40:55]
    v_cvt_pk_bf16_f32 v56, v24, v25
    v_cvt_pk_bf16_f32 v57, v26, v27
    v_cvt_pk_bf16_f32 v58, v28, v29
    v_cvt_pk_bf16_f32 v59, v30, v31
    v_exp_f32 v32, v32
    v_exp_f32 v33, v33
    v_exp_f32 v34, v34
    v_exp_f32 v35, v35
    v_mfma_f32_32x32x16_bf16 v[40:55], v[68:71], v[56:59], v[40:55]
    v_exp_f32 v36, v36
    v_exp_f32 v37, v37
    v_exp_f32 v38, v38
    v_exp_f32 v39, v39
    v_cvt_pk_bf16_f32 v60, v32, v33
    v_cvt_pk_bf16_f32 v61, v34, v35
    v_cvt_pk_bf16_f32 v62, v36, v37
    v_cvt_pk_bf16_f32 v63, v38, v39
    s_waitcnt lgkmcnt(0)
    v_mfma_f32_32x32x16_bf16 v[24:39], v[84:87], v[4:7], 0
    ds_read_b128 v[80:83], v88 offset:12384
    ds_read_b128 v[68:71], v3 offset:10320
    ds_read_b128 v[72:75], v89 offset:8256
    v_exp_f32 v8, v8
    v_exp_f32 v9, v9
    v_exp_f32 v10, v10
    v_exp_f32 v11, v11
    v_exp_f32 v12, v12
    v_exp_f32 v13, v13
    v_exp_f32 v14, v14
    v_exp_f32 v15, v15
    v_mfma_f32_32x32x16_bf16 v[40:55], v[76:79], v[60:63], v[40:55]
    v_cvt_pk_bf16_f32 v56, v8, v9
    v_cvt_pk_bf16_f32 v57, v10, v11
    v_cvt_pk_bf16_f32 v58, v12, v13
    v_cvt_pk_bf16_f32 v59, v14, v15
    v_exp_f32 v16, v16
    v_exp_f32 v17, v17
    v_exp_f32 v18, v18
    v_exp_f32 v19, v19
    v_mfma_f32_32x32x16_bf16 v[40:55], v[64:67], v[56:59], v[40:55]
    v_exp_f32 v20, v20
    v_exp_f32 v21, v21
    v_exp_f32 v22, v22
    v_exp_f32 v23, v23
    v_cvt_pk_bf16_f32 v60, v16, v17
    v_cvt_pk_bf16_f32 v61, v18, v19
    v_cvt_pk_bf16_f32 v62, v20, v21
    v_cvt_pk_bf16_f32 v63, v22, v23
    s_waitcnt lgkmcnt(0)
    v_mfma_f32_32x32x16_bf16 v[8:23], v[80:83], v[4:7], 0
    ds_read_b128 v[84:87], v88 offset:14448
    ds_read_b128 v[64:67], v3 offset:12384
    ds_read_b128 v[76:79], v89 offset:10320
    v_exp_f32 v24, v24
    v_exp_f32 v25, v25
    buffer_load_dwordx4 v[192:195], v2, s[36:39], s3 offen sc1
    v_exp_f32 v26, v26
    v_exp_f32 v27, v27
    v_exp_f32 v28, v28
    v_exp_f32 v29, v29
    v_exp_f32 v30, v30
    v_exp_f32 v31, v31
    v_mfma_f32_32x32x16_bf16 v[40:55], v[72:75], v[60:63], v[40:55]
    v_cvt_pk_bf16_f32 v56, v24, v25
    v_cvt_pk_bf16_f32 v57, v26, v27
    v_cvt_pk_bf16_f32 v58, v28, v29
    v_cvt_pk_bf16_f32 v59, v30, v31
    v_exp_f32 v32, v32
    v_exp_f32 v33, v33
    v_exp_f32 v34, v34
    v_exp_f32 v35, v35
    v_mfma_f32_32x32x16_bf16 v[40:55], v[68:71], v[56:59], v[40:55]
    v_exp_f32 v36, v36
    v_exp_f32 v37, v37
    v_exp_f32 v38, v38
    v_exp_f32 v39, v39
    v_cvt_pk_bf16_f32 v60, v32, v33
    v_cvt_pk_bf16_f32 v61, v34, v35
    v_cvt_pk_bf16_f32 v62, v36, v37
    v_cvt_pk_bf16_f32 v63, v38, v39
    s_waitcnt lgkmcnt(0)
    v_mfma_f32_32x32x16_bf16 v[24:39], v[84:87], v[4:7], 0
    ds_read_b128 v[80:83], v88 offset:16512
    ds_read_b128 v[68:71], v3 offset:14448
    ds_read_b128 v[72:75], v89 offset:12384
    v_exp_f32 v8, v8
    v_exp_f32 v9, v9
    v_exp_f32 v10, v10
    v_exp_f32 v11, v11
    v_exp_f32 v12, v12
    v_exp_f32 v13, v13
    v_exp_f32 v14, v14
    v_exp_f32 v15, v15
    v_mfma_f32_32x32x16_bf16 v[40:55], v[76:79], v[60:63], v[40:55]
    v_cvt_pk_bf16_f32 v56, v8, v9
    v_cvt_pk_bf16_f32 v57, v10, v11
    v_cvt_pk_bf16_f32 v58, v12, v13
    v_cvt_pk_bf16_f32 v59, v14, v15
    v_exp_f32 v16, v16
    v_exp_f32 v17, v17
    v_exp_f32 v18, v18
    v_exp_f32 v19, v19
    v_mfma_f32_32x32x16_bf16 v[40:55], v[64:67], v[56:59], v[40:55]
    v_exp_f32 v20, v20
    v_exp_f32 v21, v21
    v_exp_f32 v22, v22
    v_exp_f32 v23, v23
    v_cvt_pk_bf16_f32 v60, v16, v17
    v_cvt_pk_bf16_f32 v61, v18, v19
    v_cvt_pk_bf16_f32 v62, v20, v21
    v_cvt_pk_bf16_f32 v63, v22, v23
    s_waitcnt lgkmcnt(0)
    v_mfma_f32_32x32x16_bf16 v[8:23], v[80:83], v[4:7], 0
    ds_read_b128 v[84:87], v88 offset:18576
    ds_read_b128 v[64:67], v3 offset:16512
    ds_read_b128 v[76:79], v89 offset:14448
    v_exp_f32 v24, v24
    v_exp_f32 v25, v25
    v_exp_f32 v26, v26
    v_exp_f32 v27, v27
    v_exp_f32 v28, v28
    v_exp_f32 v29, v29
    v_exp_f32 v30, v30
    v_exp_f32 v31, v31
    v_mfma_f32_32x32x16_bf16 v[40:55], v[72:75], v[60:63], v[40:55]
    v_cvt_pk_bf16_f32 v56, v24, v25
    v_cvt_pk_bf16_f32 v57, v26, v27
    v_cvt_pk_bf16_f32 v58, v28, v29
    v_cvt_pk_bf16_f32 v59, v30, v31
    v_exp_f32 v32, v32
    v_exp_f32 v33, v33
    v_exp_f32 v34, v34
    v_exp_f32 v35, v35
    v_mfma_f32_32x32x16_bf16 v[40:55], v[68:71], v[56:59], v[40:55]
    v_exp_f32 v36, v36
    v_exp_f32 v37, v37
    v_exp_f32 v38, v38
    v_exp_f32 v39, v39
    v_cvt_pk_bf16_f32 v60, v32, v33
    v_cvt_pk_bf16_f32 v61, v34, v35
    v_cvt_pk_bf16_f32 v62, v36, v37
    v_cvt_pk_bf16_f32 v63, v38, v39
    v_add_u32 v88, 0x4080, v88
    v_add_u32 v3, 0x4080, v3
    v_add_u32 v89, 0x4080, v89
    s_sub_u32 s62, s62, 1
    s_waitcnt vmcnt(0)
    v_xor_b32 v192, s100, v192
    v_xor_b32 v193, s100, v193
    v_xor_b32 v194, s100, v194
    v_xor_b32 v195, s100, v195
    v_or3_b32 v192, v192, v193, v194
    v_or_b32 v192, v192, v195
    v_cmp_le_u32 vcc, 16, v192
    s_cbranch_vccnz L_attn_nf
    s_cmp_eq_u32 s63, 0
    s_cbranch_scc1 L_attn_p
    s_mov_b32 s63, 0
    s_cmp_gt_u32 s62, 3
    s_cbranch_scc1 L_attn_a
    s_branch L_attn_p
L_attn_nf:
    s_cmp_gt_u32 s62, 3
    s_cbranch_scc1 L_attn_a
    s_mov_b32 s43, 131072
    s_mov_b32 s3, 0x30400
L_poll_6:
    buffer_load_dwordx4 v[192:195], v2, s[36:39], s3 offen sc1
L_pc_8:
    s_waitcnt vmcnt(0)
    v_xor_b32 v192, s100, v192
    v_xor_b32 v193, s100, v193
    v_xor_b32 v194, s100, v194
    v_xor_b32 v195, s100, v195
    v_or3_b32 v192, v192, v193, v194
    v_or_b32 v192, v192, v195
    v_cmp_le_u32 vcc, 16, v192
    s_cbranch_vccz L_pd_7
    s_sub_u32 s43, s43, 1
    s_cmp_lg_u32 s43, 0
    s_sleep 2
    s_cbranch_scc1 L_poll_6
L_pd_7:
L_attn_p:
    s_setprio 3
    s_cmp_ge_u32 s62, 5
    s_cbranch_scc1 L_fp_9
    s_setprio 2
    s_cmp_ge_u32 s62, 3
    s_cbranch_scc1 L_fp_9
    s_setprio 1
    s_cmp_ge_u32 s62, 2
    s_cbranch_scc1 L_fp_9
    s_setprio 0
L_fp_9:
    s_nop 1
    s_waitcnt lgkmcnt(0)
    v_mfma_f32_32x32x16_bf16 v[24:39], v[84:87], v[4:7], 0
    ds_read_b128 v[80:83], v88 offset:4128
    ds_read_b128 v[68:71], v3 offset:2064
    ds_read_b128 v[72:75], v89 offset:0
    v_exp_f32 v8, v8
    v_exp_f32 v9, v9
    s_lshr_b32 s51, s42, 1
    s_lshl_b32 s51, s51, 3
    s_lshl_b32 s52, s40, 6
    s_add_u32 s51, s51, s52
    s_lshl_b32 s51, s51, 10
    s_add_u32 s51, s51, 0x240000
    s_add_u32 s52, s51, 32768
    buffer_load_dwordx4 v[192:195], v2, s[36:39], s51 offen offset:0 sc1
    v_exp_f32 v10, v10
    v_exp_f32 v11, v11
    buffer_load_dwordx4 v[224:227], v2, s[36:39], s52 offen offset:0 sc1
    v_exp_f32 v12, v12
    v_exp_f32 v13, v13
    buffer_load_dwordx4 v[196:199], v2, s[36:39], s51 offen offset:1024 sc1
    v_exp_f32 v14, v14
    v_exp_f32 v15, v15
    v_mfma_f32_32x32x16_bf16 v[40:55], v[76:79], v[60:63], v[40:55]
    v_cvt_pk_bf16_f32 v56, v8, v9
    v_cvt_pk_bf16_f32 v57, v10, v11
    v_cvt_pk_bf16_f32 v58, v12, v13
    v_cvt_pk_bf16_f32 v59, v14, v15
    v_exp_f32 v16, v16
    buffer_load_dwordx4 v[228:231], v2, s[36:39], s52 offen offset:1024 sc1
    v_exp_f32 v17, v17
    buffer_load_dwordx4 v[200:203], v2, s[36:39], s51 offen offset:2048 sc1
    v_exp_f32 v18, v18
    v_exp_f32 v19, v19
    v_mfma_f32_32x32x16_bf16 v[40:55], v[64:67], v[56:59], v[40:55]
    v_exp_f32 v20, v20
    v_exp_f32 v21, v21
    v_exp_f32 v22, v22
    v_exp_f32 v23, v23
    v_cvt_pk_bf16_f32 v60, v16, v17
    v_cvt_pk_bf16_f32 v61, v18, v19
    v_cvt_pk_bf16_f32 v62, v20, v21
    v_cvt_pk_bf16_f32 v63, v22, v23
    s_waitcnt lgkmcnt(0)
    v_mfma_f32_32x32x16_bf16 v[8:23], v[80:83], v[4:7], 0
    ds_read_b128 v[84:87], v88 offset:6192
    ds_read_b128 v[64:67], v3 offset:4128
    ds_read_b128 v[76:79], v89 offset:2064
    v_exp_f32 v24, v24
    v_exp_f32 v25, v25
    buffer_load_dwordx4 v[232:235], v2, s[36:39], s52 offen offset:2048 sc1
    v_exp_f32 v26, v26
    v_exp_f32 v27, v27
    buffer_load_dwordx4 v[204:207], v2, s[36:39], s51 offen offset:3072 sc1
    v_exp_f32 v28, v28
    v_exp_f32 v29, v29
    buffer_load_dwordx4 v[236:239], v2, s[36:39], s52 offen offset:3072 sc1
    v_exp_f32 v30, v30
    v_exp_f32 v31, v31
    v_mfma_f32_32x32x16_bf16 v[40:55], v[72:75], v[60:63], v[40:55]
    v_cvt_pk_bf16_f32 v56, v24, v25
    v_cvt_pk_bf16_f32 v57, v26, v27
    v_cvt_pk_bf16_f32 v58, v28, v29
    v_cvt_pk_bf16_f32 v59, v30, v31
    v_exp_f32 v32, v32
    s_add_u32 s51, s51, 4096
    buffer_load_dwordx4 v[208:211], v2, s[36:39], s51 offen offset:0 sc1
    v_exp_f32 v33, v33
    s_add_u32 s52, s52, 4096
    buffer_load_dwordx4 v[240:243], v2, s[36:39], s52 offen offset:0 sc1
    v_exp_f32 v34, v34
    v_exp_f32 v35, v35
    v_mfma_f32_32x32x16_bf16 v[40:55], v[68:71], v[56:59], v[40:55]
    v_exp_f32 v36, v36
    v_exp_f32 v37, v37
    v_exp_f32 v38, v38
    v_exp_f32 v39, v39
    v_cvt_pk_bf16_f32 v60, v32, v33
    v_cvt_pk_bf16_f32 v61, v34, v35
    v_cvt_pk_bf16_f32 v62, v36, v37
    v_cvt_pk_bf16_f32 v63, v38, v39
    s_waitcnt lgkmcnt(0)
    v_mfma_f32_32x32x16_bf16 v[24:39], v[84:87], v[4:7], 0
    ds_read_b128 v[80:83], v88 offset:8256
    ds_read_b128 v[68:71], v3 offset:6192
    ds_read_b128 v[72:75], v89 offset:4128
    v_exp_f32 v8, v8
    v_exp_f32 v9, v9
    buffer_load_dwordx4 v[212:215], v2, s[36:39], s51 offen offset:1024 sc1
    v_exp_f32 v10, v10
    v_exp_f32 v11, v11
    buffer_load_dwordx4 v[244:247], v2, s[36:39], s52 offen offset:1024 sc1
    v_exp_f32 v12, v12
    v_exp_f32 v13, v13
    buffer_load_dwordx4 v[216:219], v2, s[36:39], s51 offen offset:2048 sc1
    v_exp_f32 v14, v14
    v_exp_f32 v15, v15
    v_mfma_f32_32x32x16_bf16 v[40:55], v[76:79], v[60:63], v[40:55]
    v_cvt_pk_bf16_f32 v56, v8, v9
    v_cvt_pk_bf16_f32 v57, v10, v11
    v_cvt_pk_bf16_f32 v58, v12, v13
    v_cvt_pk_bf16_f32 v59, v14, v15
    v_exp_f32 v16, v16
    buffer_load_dwordx4 v[248:251], v2, s[36:39], s52 offen offset:2048 sc1
    v_exp_f32 v17, v17
    buffer_load_dwordx4 v[220:223], v2, s[36:39], s51 offen offset:3072 sc1
    v_exp_f32 v18, v18
    v_exp_f32 v19, v19
    v_mfma_f32_32x32x16_bf16 v[40:55], v[64:67], v[56:59], v[40:55]
    v_exp_f32 v20, v20
    v_exp_f32 v21, v21
    v_exp_f32 v22, v22
    v_exp_f32 v23, v23
    v_cvt_pk_bf16_f32 v60, v16, v17
    v_cvt_pk_bf16_f32 v61, v18, v19
    v_cvt_pk_bf16_f32 v62, v20, v21
    v_cvt_pk_bf16_f32 v63, v22, v23
    s_waitcnt lgkmcnt(0)
    v_mfma_f32_32x32x16_bf16 v[8:23], v[80:83], v[4:7], 0
    ds_read_b128 v[84:87], v88 offset:10320
    ds_read_b128 v[64:67], v3 offset:8256
    ds_read_b128 v[76:79], v89 offset:6192
    v_exp_f32 v24, v24
    v_exp_f32 v25, v25
    buffer_load_dwordx4 v[252:255], v2, s[36:39], s52 offen offset:3072 sc1
    v_exp_f32 v26, v26
    v_exp_f32 v27, v27
    s_and_b32 s3, s42, 1
    s_lshl_b32 s43, s41, 1
    s_add_u32 s3, s3, s43
    s_lshl_b32 s3, s3, 15
    s_lshl_b32 s43, s40, 7
    s_add_u32 s3, s3, s43
    s_lshr_b32 s43, s42, 1
    s_lshl_b32 s43, s43, 5
    s_add_u32 s53, s3, s43
    buffer_load_dwordx4 v[92:95], v90, s[4:7], s53 offen
    v_exp_f32 v28, v28
    v_exp_f32 v29, v29
    s_mul_i32 s54, s40, 7
    s_add_u32 s54, s54, s42
    s_lshl_b32 s54, s54, 15
    s_add_u32 s54, s54, 0x2c0000
    s_mul_i32 s55, s40, 224
    s_mul_i32 s43, s42, 14
    s_add_u32 s55, s55, s43
    s_lshl_b32 s55, s55, 10
    s_add_u32 s55, s55, 0x480000
    s_add_u32 s56, s55, 8192
    s_cmp_eq_u32 s42, 7
    s_cselect_b32 s57, s56, s54
    s_cselect_b32 s58, 100352, 0
    buffer_load_dwordx4 v[96:99], v2, s[36:39], s57 offen offset:0 sc1
    v_exp_f32 v30, v30
    v_exp_f32 v31, v31
    v_mfma_f32_32x32x16_bf16 v[40:55], v[72:75], v[60:63], v[40:55]
    v_cvt_pk_bf16_f32 v56, v24, v25
    v_cvt_pk_bf16_f32 v57, v26, v27
    v_cvt_pk_bf16_f32 v58, v28, v29
    v_cvt_pk_bf16_f32 v59, v30, v31
    v_exp_f32 v32, v32
    buffer_load_dwordx4 v[100:103], v2, s[36:39], s57 offen offset:1024 sc1
    v_exp_f32 v33, v33
    buffer_load_dwordx4 v[104:107], v2, s[36:39], s57 offen offset:2048 sc1
    v_exp_f32 v34, v34
    v_exp_f32 v35, v35
    v_mfma_f32_32x32x16_bf16 v[40:55], v[68:71], v[56:59], v[40:55]
    v_exp_f32 v36, v36
    v_exp_f32 v37, v37
    v_exp_f32 v38, v38
    v_exp_f32 v39, v39
    v_cvt_pk_bf16_f32 v60, v32, v33
    v_cvt_pk_bf16_f32 v61, v34, v35
    v_cvt_pk_bf16_f32 v62, v36, v37
    v_cvt_pk_bf16_f32 v63, v38, v39
    s_waitcnt lgkmcnt(0)
    v_mfma_f32_32x32x16_bf16 v[24:39], v[84:87], v[4:7], 0
    ds_read_b128 v[80:83], v88 offset:12384
    ds_read_b128 v[68:71], v3 offset:10320
    ds_read_b128 v[72:75], v89 offset:8256
    v_exp_f32 v8, v8
    v_exp_f32 v9, v9
    buffer_load_dwordx4 v[108:111], v2, s[36:39], s57 offen offset:3072 sc1
    v_exp_f32 v10, v10
    v_exp_f32 v11, v11
    s_add_u32 s57, s57, 4096
    buffer_load_dwordx4 v[112:115], v2, s[36:39], s57 offen offset:0 sc1
    v_exp_f32 v12, v12
    v_exp_f32 v13, v13
    buffer_load_dwordx4 v[116:119], v2, s[36:39], s57 offen offset:1024 sc1
    v_exp_f32 v14, v14
    v_exp_f32 v15, v15
    v_mfma_f32_32x32x16_bf16 v[40:55], v[76:79], v[60:63], v[40:55]
    v_cvt_pk_bf16_f32 v56, v8, v9
    v_cvt_pk_bf16_f32 v57, v10, v11
    v_cvt_pk_bf16_f32 v58, v12, v13
    v_cvt_pk_bf16_f32 v59, v14, v15
    v_exp_f32 v16, v16
    s_add_u32 s57, s57, 2048
    s_add_u32 s57, s57, s58
    buffer_load_dwordx4 v[120:123], v2, s[36:39], s57 offen offset:0 sc1
    v_exp_f32 v17, v17
    buffer_load_dwordx4 v[124:127], v2, s[36:39], s57 offen offset:1024 sc1
    v_exp_f32 v18, v18
    v_exp_f32 v19, v19
    v_mfma_f32_32x32x16_bf16 v[40:55], v[64:67], v[56:59], v[40:55]
    v_exp_f32 v20, v20
    v_exp_f32 v21, v21
    v_exp_f32 v22, v22
    v_exp_f32 v23, v23
    v_cvt_pk_bf16_f32 v60, v16, v17
    v_cvt_pk_bf16_f32 v61, v18, v19
    v_cvt_pk_bf16_f32 v62, v20, v21
    v_cvt_pk_bf16_f32 v63, v22, v23
    s_waitcnt lgkmcnt(0)
    v_mfma_f32_32x32x16_bf16 v[8:23], v[80:83], v[4:7], 0
    ds_read_b128 v[84:87], v88 offset:14448
    ds_read_b128 v[64:67], v3 offset:12384
    ds_read_b128 v[76:79], v89 offset:10320
    v_exp_f32 v24, v24
    v_exp_f32 v25, v25
    buffer_load_dwordx4 v[128:131], v2, s[36:39], s57 offen offset:2048 sc1
    v_exp_f32 v26, v26
    v_exp_f32 v27, v27
    buffer_load_dwordx4 v[132:135], v2, s[36:39], s57 offen offset:3072 sc1
    v_exp_f32 v28, v28
    v_exp_f32 v29, v29
    s_add_u32 s57, s57, 4096
    buffer_load_dwordx4 v[136:139], v2, s[36:39], s57 offen offset:0 sc1
    v_exp_f32 v30, v30
    v_exp_f32 v31, v31
    v_mfma_f32_32x32x16_bf16 v[40:55], v[72:75], v[60:63], v[40:55]
    v_cvt_pk_bf16_f32 v56, v24, v25
    v_cvt_pk_bf16_f32 v57, v26, v27
    v_cvt_pk_bf16_f32 v58, v28, v29
    v_cvt_pk_bf16_f32 v59, v30, v31
    v_exp_f32 v32, v32
    buffer_load_dwordx4 v[140:143], v2, s[36:39], s57 offen offset:1024 sc1
    v_exp_f32 v33, v33
    buffer_load_dwordx4 v[144:147], v2, s[36:39], s57 offen offset:2048 sc1
    v_exp_f32 v34, v34
    v_exp_f32 v35, v35
    v_mfma_f32_32x32x16_bf16 v[40:55], v[68:71], v[56:59], v[40:55]
    v_exp_f32 v36, v36
    v_exp_f32 v37, v37
    v_exp_f32 v38, v38
    v_exp_f32 v39, v39
    v_cvt_pk_bf16_f32 v60, v32, v33
    v_cvt_pk_bf16_f32 v61, v34, v35
    v_cvt_pk_bf16_f32 v62, v36, v37
    v_cvt_pk_bf16_f32 v63, v38, v39
    s_waitcnt lgkmcnt(0)
    v_mfma_f32_32x32x16_bf16 v[24:39], v[84:87], v[4:7], 0
    ds_read_b128 v[80:83], v88 offset:16512
    ds_read_b128 v[68:71], v3 offset:14448
    ds_read_b128 v[72:75], v89 offset:12384
    v_exp_f32 v8, v8
    v_exp_f32 v9, v9
    buffer_load_dwordx4 v[148:151], v2, s[36:39], s57 offen offset:3072 sc1
    v_exp_f32 v10, v10
    v_exp_f32 v11, v11
    s_add_u32 s57, s57, 4096
    buffer_load_dwordx4 v[152:155], v2, s[36:39], s57 offen offset:0 sc1
    v_exp_f32 v12, v12
    v_exp_f32 v13, v13
    buffer_load_dwordx4 v[156:159], v2, s[36:39], s57 offen offset:1024 sc1
    v_exp_f32 v14, v14
    v_exp_f32 v15, v15
    v_mfma_f32_32x32x16_bf16 v[40:55], v[76:79], v[60:63], v[40:55]
    v_cvt_pk_bf16_f32 v56, v8, v9
    v_cvt_pk_bf16_f32 v57, v10, v11
    v_cvt_pk_bf16_f32 v58, v12, v13
    v_cvt_pk_bf16_f32 v59, v14, v15
    v_exp_f32 v16, v16
    buffer_load_dwordx4 v[160:163], v2, s[36:39], s57 offen offset:2048 sc1
    v_exp_f32 v17, v17
    buffer_load_dwordx4 v[164:167], v2, s[36:39], s57 offen offset:3072 sc1
    v_exp_f32 v18, v18
    v_exp_f32 v19, v19
    v_mfma_f32_32x32x16_bf16 v[40:55], v[64:67], v[56:59], v[40:55]
    v_exp_f32 v20, v20
    v_exp_f32 v21, v21
    v_exp_f32 v22, v22
    v_exp_f32 v23, v23
    v_cvt_pk_bf16_f32 v60, v16, v17
    v_cvt_pk_bf16_f32 v61, v18, v19
    v_cvt_pk_bf16_f32 v62, v20, v21
    v_cvt_pk_bf16_f32 v63, v22, v23
    s_waitcnt lgkmcnt(0)
    v_mfma_f32_32x32x16_bf16 v[8:23], v[80:83], v[4:7], 0
    ds_read_b128 v[84:87], v88 offset:18576
    ds_read_b128 v[64:67], v3 offset:16512
    ds_read_b128 v[76:79], v89 offset:14448
    v_exp_f32 v24, v24
    v_exp_f32 v25, v25
    s_add_u32 s57, s57, 4096
    buffer_load_dwordx4 v[168:171], v2, s[36:39], s57 offen offset:0 sc1
    v_exp_f32 v26, v26
    v_exp_f32 v27, v27
    buffer_load_dwordx4 v[172:175], v2, s[36:39], s57 offen offset:1024 sc1
    v_exp_f32 v28, v28
    v_exp_f32 v29, v29
    buffer_load_dwordx4 v[176:179], v2, s[36:39], s57 offen offset:2048 sc1
    v_exp_f32 v30, v30
    v_exp_f32 v31, v31
    v_mfma_f32_32x32x16_bf16 v[40:55], v[72:75], v[60:63], v[40:55]
    v_cvt_pk_bf16_f32 v56, v24, v25
    v_cvt_pk_bf16_f32 v57, v26, v27
    v_cvt_pk_bf16_f32 v58, v28, v29
    v_cvt_pk_bf16_f32 v59, v30, v31
    v_exp_f32 v32, v32
    buffer_load_dwordx4 v[180:183], v2, s[36:39], s57 offen offset:3072 sc1
    v_exp_f32 v33, v33
    s_add_u32 s57, s57, 4096
    buffer_load_dwordx4 v[184:187], v2, s[36:39], s57 offen offset:0 sc1
    v_exp_f32 v34, v34
    buffer_load_dwordx4 v[188:191], v2, s[36:39], s57 offen offset:1024 sc1
    v_exp_f32 v35, v35
    v_mfma_f32_32x32x16_bf16 v[40:55], v[68:71], v[56:59], v[40:55]
    v_exp_f32 v36, v36
    v_exp_f32 v37, v37
    v_exp_f32 v38, v38
    v_exp_f32 v39, v39
    v_cvt_pk_bf16_f32 v60, v32, v33
    v_cvt_pk_bf16_f32 v61, v34, v35
    v_cvt_pk_bf16_f32 v62, v36, v37
    v_cvt_pk_bf16_f32 v63, v38, v39
    v_add_u32 v88, 0x4080, v88
    v_add_u32 v3, 0x4080, v3
    v_add_u32 v89, 0x4080, v89
    s_sub_u32 s62, s62, 1
.p2align 6
L_attn_b:
    s_setprio 3
    s_cmp_ge_u32 s62, 5
    s_cbranch_scc1 L_fp_10
    s_setprio 2
    s_cmp_ge_u32 s62, 3
    s_cbranch_scc1 L_fp_10
    s_setprio 1
    s_cmp_ge_u32 s62, 2
    s_cbranch_scc1 L_fp_10
    s_setprio 0
L_fp_10:
    s_waitcnt lgkmcnt(0)
    v_mfma_f32_32x32x16_bf16 v[24:39], v[84:87], v[4:7], 0
    ds_read_b128 v[80:83], v88 offset:4128
    ds_read_b128 v[68:71], v3 offset:2064
    ds_read_b128 v[72:75], v89 offset:0
    v_exp_f32 v8, v8
    v_exp_f32 v9, v9
    v_exp_f32 v10, v10
    v_exp_f32 v11, v11
    v_exp_f32 v12, v12
    v_exp_f32 v13, v13
    v_exp_f32 v14, v14
    v_exp_f32 v15, v15
    v_mfma_f32_32x32x16_bf16 v[40:55], v[76:79], v[60:63], v[40:55]
    v_cvt_pk_bf16_f32 v56, v8, v9
    v_cvt_pk_bf16_f32 v57, v10, v11
    v_cvt_pk_bf16_f32 v58, v12, v13
    v_cvt_pk_bf16_f32 v59, v14, v15
    v_exp_f32 v16, v16
    v_exp_f32 v17, v17
    v_exp_f32 v18, v18
    v_exp_f32 v19, v19
    v_mfma_f32_32x32x16_bf16 v[40:55], v[64:67], v[56:59], v[40:55]
    v_exp_f32 v20, v20
    v_exp_f32 v21, v21
    v_exp_f32 v22, v22
    v_exp_f32 v23, v23
    v_cvt_pk_bf16_f32 v60, v16, v17
    v_cvt_pk_bf16_f32 v61, v18, v19
    v_cvt_pk_bf16_f32 v62, v20, v21
    v_cvt_pk_bf16_f32 v63, v22, v23
    s_waitcnt lgkmcnt(0)
    v_mfma_f32_32x32x16_bf16 v[8:23], v[80:83], v[4:7], 0
    ds_read_b128 v[84:87], v88 offset:6192
    ds_read_b128 v[64:67], v3 offset:4128
    ds_read_b128 v[76:79], v89 offset:2064
    v_exp_f32 v24, v24
    v_exp_f32 v25, v25
    v_exp_f32 v26, v26
    v_exp_f32 v27, v27
    v_exp_f32 v28, v28
    v_exp_f32 v29, v29
    v_exp_f32 v30, v30
    v_exp_f32 v31, v31
    v_mfma_f32_32x32x16_bf16 v[40:55], v[72:75], v[60:63], v[40:55]
    v_cvt_pk_bf16_f32 v56, v24, v25
    v_cvt_pk_bf16_f32 v57, v26, v27
    v_cvt_pk_bf16_f32 v58, v28, v29
    v_cvt_pk_bf16_f32 v59, v30, v31
    v_exp_f32 v32, v32
    v_exp_f32 v33, v33
    v_exp_f32 v34, v34
    v_exp_f32 v35, v35
    v_mfma_f32_32x32x16_bf16 v[40:55], v[68:71], v[56:59], v[40:55]
    v_exp_f32 v36, v36
    v_exp_f32 v37, v37
    v_exp_f32 v38, v38
    v_exp_f32 v39, v39
    v_cvt_pk_bf16_f32 v60, v32, v33
    v_cvt_pk_bf16_f32 v61, v34, v35
    v_cvt_pk_bf16_f32 v62, v36, v37
    v_cvt_pk_bf16_f32 v63, v38, v39
    s_waitcnt lgkmcnt(0)
    v_mfma_f32_32x32x16_bf16 v[24:39], v[84:87], v[4:7], 0
    ds_read_b128 v[80:83], v88 offset:8256
    ds_read_b128 v[68:71], v3 offset:6192
    ds_read_b128 v[72:75], v89 offset:4128
    v_exp_f32 v8, v8
    v_exp_f32 v9, v9
    v_exp_f32 v10, v10
    v_exp_f32 v11, v11
    v_exp_f32 v12, v12
    v_exp_f32 v13, v13
    v_exp_f32 v14, v14
    v_exp_f32 v15, v15
    v_mfma_f32_32x32x16_bf16 v[40:55], v[76:79], v[60:63], v[40:55]
    v_cvt_pk_bf16_f32 v56, v8, v9
    v_cvt_pk_bf16_f32 v57, v10, v11
    v_cvt_pk_bf16_f32 v58, v12, v13
    v_cvt_pk_bf16_f32 v59, v14, v15
    v_exp_f32 v16, v16
    v_exp_f32 v17, v17
    v_exp_f32 v18, v18
    v_exp_f32 v19, v19
    v_mfma_f32_32x32x16_bf16 v[40:55], v[64:67], v[56:59], v[40:55]
    v_exp_f32 v20, v20
    v_exp_f32 v21, v21
    v_exp_f32 v22, v22
    v_exp_f32 v23, v23
    v_cvt_pk_bf16_f32 v60, v16, v17
    v_cvt_pk_bf16_f32 v61, v18, v19
    v_cvt_pk_bf16_f32 v62, v20, v21
    v_cvt_pk_bf16_f32 v63, v22, v23
    s_waitcnt lgkmcnt(0)
    v_mfma_f32_32x32x16_bf16 v[8:23], v[80:83], v[4:7], 0
    ds_read_b128 v[84:87], v88 offset:10320
    ds_read_b128 v[64:67], v3 offset:8256
    ds_read_b128 v[76:79], v89 offset:6192
    v_exp_f32 v24, v24
    v_exp_f32 v25, v25
    v_exp_f32 v26, v26
    v_exp_f32 v27, v27
    v_exp_f32 v28, v28
    v_exp_f32 v29, v29
    v_exp_f32 v30, v30
    v_exp_f32 v31, v31
    v_mfma_f32_32x32x16_bf16 v[40:55], v[72:75], v[60:63], v[40:55]
    v_cvt_pk_bf16_f32 v56, v24, v25
    v_cvt_pk_bf16_f32 v57, v26, v27
    v_cvt_pk_bf16_f32 v58, v28, v29
    v_cvt_pk_bf16_f32 v59, v30, v31
    v_exp_f32 v32, v32
    v_exp_f32 v33, v33
    v_exp_f32 v34, v34
    v_exp_f32 v35, v35
    v_mfma_f32_32x32x16_bf16 v[40:55], v[68:71], v[56:59], v[40:55]
    v_exp_f32 v36, v36
    v_exp_f32 v37, v37
    v_exp_f32 v38, v38
    v_exp_f32 v39, v39
    v_cvt_pk_bf16_f32 v60, v32, v33
    v_cvt_pk_bf16_f32 v61, v34, v35
    v_cvt_pk_bf16_f32 v62, v36, v37
    v_cvt_pk_bf16_f32 v63, v38, v39
    s_waitcnt lgkmcnt(0)
    v_mfma_f32_32x32x16_bf16 v[24:39], v[84:87], v[4:7], 0
    ds_read_b128 v[80:83], v88 offset:12384
    ds_read_b128 v[68:71], v3 offset:10320
    ds_read_b128 v[72:75], v89 offset:8256
    v_exp_f32 v8, v8
    v_exp_f32 v9, v9
    v_exp_f32 v10, v10
    v_exp_f32 v11, v11
    v_exp_f32 v12, v12
    v_exp_f32 v13, v13
    v_exp_f32 v14, v14
    v_exp_f32 v15, v15
    v_mfma_f32_32x32x16_bf16 v[40:55], v[76:79], v[60:63], v[40:55]
    v_cvt_pk_bf16_f32 v56, v8, v9
    v_cvt_pk_bf16_f32 v57, v10, v11
    v_cvt_pk_bf16_f32 v58, v12, v13
    v_cvt_pk_bf16_f32 v59, v14, v15
    v_exp_f32 v16, v16
    v_exp_f32 v17, v17
    v_exp_f32 v18, v18
    v_exp_f32 v19, v19
    v_mfma_f32_32x32x16_bf16 v[40:55], v[64:67], v[56:59], v[40:55]
    v_exp_f32 v20, v20
    v_exp_f32 v21, v21
    v_exp_f32 v22, v22
    v_exp_f32 v23, v23
    v_cvt_pk_bf16_f32 v60, v16, v17
    v_cvt_pk_bf16_f32 v61, v18, v19
    v_cvt_pk_bf16_f32 v62, v20, v21
    v_cvt_pk_bf16_f32 v63, v22, v23
    s_waitcnt lgkmcnt(0)
    v_mfma_f32_32x32x16_bf16 v[8:23], v[80:83], v[4:7], 0
    ds_read_b128 v[84:87], v88 offset:14448
    ds_read_b128 v[64:67], v3 offset:12384
    ds_read_b128 v[76:79], v89 offset:10320
    v_exp_f32 v24, v24
    v_exp_f32 v25, v25
    v_exp_f32 v26, v26
    v_exp_f32 v27, v27
    v_exp_f32 v28, v28
    v_exp_f32 v29, v29
    v_exp_f32 v30, v30
    v_exp_f32 v31, v31
    v_mfma_f32_32x32x16_bf16 v[40:55], v[72:75], v[60:63], v[40:55]
    v_cvt_pk_bf16_f32 v56, v24, v25
    v_cvt_pk_bf16_f32 v57, v26, v27
    v_cvt_pk_bf16_f32 v58, v28, v29
    v_cvt_pk_bf16_f32 v59, v30, v31
    v_exp_f32 v32, v32
    v_exp_f32 v33, v33
    v_exp_f32 v34, v34
    v_exp_f32 v35, v35
    v_mfma_f32_32x32x16_bf16 v[40:55], v[68:71], v[56:59], v[40:55]
    v_exp_f32 v36, v36
    v_exp_f32 v37, v37
    v_exp_f32 v38, v38
    v_exp_f32 v39, v39
    v_cvt_pk_bf16_f32 v60, v32, v33
    v_cvt_pk_bf16_f32 v61, v34, v35
    v_cvt_pk_bf16_f32 v62, v36, v37
    v_cvt_pk_bf16_f32 v63, v38, v39
    s_waitcnt lgkmcnt(0)
    v_mfma_f32_32x32x16_bf16 v[24:39], v[84:87], v[4:7], 0
    ds_read_b128 v[80:83], v88 offset:16512
    ds_read_b128 v[68:71], v3 offset:14448
    ds_read_b128 v[72:75], v89 offset:12384
    v_exp_f32 v8, v8
    v_exp_f32 v9, v9
    v_exp_f32 v10, v10
    v_exp_f32 v11, v11
    v_exp_f32 v12, v12
    v_exp_f32 v13, v13
    v_exp_f32 v14, v14
    v_exp_f32 v15, v15
    v_mfma_f32_32x32x16_bf16 v[40:55], v[76:79], v[60:63], v[40:55]
    v_cvt_pk_bf16_f32 v56, v8, v9
    v_cvt_pk_bf16_f32 v57, v10, v11
    v_cvt_pk_bf16_f32 v58, v12, v13
    v_cvt_pk_bf16_f32 v59, v14, v15
    v_exp_f32 v16, v16
    v_exp_f32 v17, v17
    v_exp_f32 v18, v18
    v_exp_f32 v19, v19
    v_mfma_f32_32x32x16_bf16 v[40:55], v[64:67], v[56:59], v[40:55]
    v_exp_f32 v20, v20
    v_exp_f32 v21, v21
    v_exp_f32 v22, v22
    v_exp_f32 v23, v23
    v_cvt_pk_bf16_f32 v60, v16, v17
    v_cvt_pk_bf16_f32 v61, v18, v19
    v_cvt_pk_bf16_f32 v62, v20, v21
    v_cvt_pk_bf16_f32 v63, v22, v23
    s_waitcnt lgkmcnt(0)
    v_mfma_f32_32x32x16_bf16 v[8:23], v[80:83], v[4:7], 0
    ds_read_b128 v[84:87], v88 offset:18576
    ds_read_b128 v[64:67], v3 offset:16512
    ds_read_b128 v[76:79], v89 offset:14448
    v_exp_f32 v24, v24
    v_exp_f32 v25, v25
    v_exp_f32 v26, v26
    v_exp_f32 v27, v27
    v_exp_f32 v28, v28
    v_exp_f32 v29, v29
    v_exp_f32 v30, v30
    v_exp_f32 v31, v31
    v_mfma_f32_32x32x16_bf16 v[40:55], v[72:75], v[60:63], v[40:55]
    v_cvt_pk_bf16_f32 v56, v24, v25
    v_cvt_pk_bf16_f32 v57, v26, v27
    v_cvt_pk_bf16_f32 v58, v28, v29
    v_cvt_pk_bf16_f32 v59, v30, v31
    v_exp_f32 v32, v32
    v_exp_f32 v33, v33
    v_exp_f32 v34, v34
    v_exp_f32 v35, v35
    v_mfma_f32_32x32x16_bf16 v[40:55], v[68:71], v[56:59], v[40:55]
    v_exp_f32 v36, v36
    v_exp_f32 v37, v37
    v_exp_f32 v38, v38
    v_exp_f32 v39, v39
    v_cvt_pk_bf16_f32 v60, v32, v33
    v_cvt_pk_bf16_f32 v61, v34, v35
    v_cvt_pk_bf16_f32 v62, v36, v37
    v_cvt_pk_bf16_f32 v63, v38, v39
    v_add_u32 v88, 0x4080, v88
    v_add_u32 v3, 0x4080, v3
    v_add_u32 v89, 0x4080, v89
    s_sub_u32 s62, s62, 1
    s_cmp_lg_u32 s62, 0
    s_cbranch_scc1 L_attn_b
    s_setprio 0
    s_waitcnt lgkmcnt(0)
    v_mfma_f32_32x32x16_bf16 v[40:55], v[76:79], v[60:63], v[40:55]
    s_branch L_attn_fin
L_attn_fb:
    s_nop 3
    s_mov_b32 m0, s19
    s_add_u32 s19, s19, 16512
    buffer_load_dwordx4 v2, s[36:39], s18 offen sc1 lds
    buffer_load_dwordx4 v2, s[36:39], s18 offen offset:1024 sc1 lds
    s_add_u32 s18, s18, 16384
    s_mov_b32 m0, s19
    s_add_u32 s19, s19, 16512
    buffer_load_dwordx4 v2, s[36:39], s18 offen sc1 lds
    buffer_load_dwordx4 v2, s[36:39], s18 offen offset:1024 sc1 lds
    s_add_u32 s18, s18, 16384
    s_mov_b32 m0, s19
    s_add_u32 s19, s19, 16512
    buffer_load_dwordx4 v2, s[36:39], s18 offen sc1 lds
    buffer_load_dwordx4 v2, s[36:39], s18 offen offset:1024 sc1 lds
    s_add_u32 s18, s18, 16384
    s_mov_b32 m0, s19
    s_add_u32 s19, s19, 16512
    buffer_load_dwordx4 v2, s[36:39], s18 offen sc1 lds
    buffer_load_dwordx4 v2, s[36:39], s18 offen offset:1024 sc1 lds
    s_add_u32 s18, s18, 16384
    s_mov_b32 m0, s19
    s_add_u32 s19, s19, 16512
    buffer_load_dwordx4 v2, s[36:39], s18 offen sc1 lds
    buffer_load_dwordx4 v2, s[36:39], s18 offen offset:1024 sc1 lds
    s_add_u32 s18, s18, 16384
    s_mov_b32 m0, s19
    s_add_u32 s19, s19, 16512
    buffer_load_dwordx4 v2, s[36:39], s18 offen sc1 lds
    buffer_load_dwordx4 v2, s[36:39], s18 offen offset:1024 sc1 lds
    s_add_u32 s18, s18, 16384
    s_mov_b32 m0, s19
    s_add_u32 s19, s19, 16512
    buffer_load_dwordx4 v2, s[36:39], s18 offen sc1 lds
    buffer_load_dwordx4 v2, s[36:39], s18 offen offset:1024 sc1 lds
    s_add_u32 s18, s18, 16384
    s_mov_b32 m0, s60
    s_add_u32 s60, s60, 1024
    buffer_load_dwordx4 v99, s[52:55], s57 offen lds
    s_lshl_b32 s61, s56, 3
    s_add_u32 s57, s57, s61
    s_mov_b32 m0, s60
    s_add_u32 s60, s60, 1024
    buffer_load_dwordx4 v99, s[52:55], s57 offen lds
    s_waitcnt vmcnt(0)
    ds_read_b64_tr_b16 v[104:105], v100
    ds_read_b64_tr_b16 v[106:107], v100 offset:1024
    ds_read_b64_tr_b16 v[108:109], v101
    ds_read_b64_tr_b16 v[110:111], v101 offset:1024
    s_waitcnt lgkmcnt(0)
    buffer_store_dwordx4 v[104:107], v2, s[36:39], s58 offen sc1
    s_add_u32 s58, s58, s59
    buffer_store_dwordx4 v[108:111], v2, s[36:39], s58 offen sc1
    s_barrier
    s_waitcnt vmcnt(0)
    s_barrier
    s_cmp_lg_u32 s42, 7
    s_cbranch_scc1 L_f2_11
    s_lshl_b32 s18, s2, 2
    s_add_u32 s18, s18, 0x30400
    v_mov_b32 v96, s100
    s_mov_b64 exec, 1
    buffer_store_dword v96, off, s[36:39], s18 sc1
    s_mov_b64 exec, -1
L_f2_11:
    v_mov_b32 v40, 0
    v_mov_b32 v41, 0
    v_mov_b32 v42, 0
    v_mov_b32 v43, 0
    v_mov_b32 v44, 0
    v_mov_b32 v45, 0
    v_mov_b32 v46, 0
    v_mov_b32 v47, 0
    v_mov_b32 v48, 0
    v_mov_b32 v49, 0
    v_mov_b32 v50, 0
    v_mov_b32 v51, 0
    v_mov_b32 v52, 0
    v_mov_b32 v53, 0
    v_mov_b32 v54, 0
    v_mov_b32 v55, 0
    v_mov_b32 v24, 0xff7fffff
    s_mov_b32 s62, 64
    s_nop 3
L_attn_slow:
    ds_read_b128 v[80:83], v88
    ds_read_b128 v[64:67], v3
    ds_read_b128 v[68:71], v89
    v_add_u32 v88, 0x810, v88
    v_add_u32 v3, 0x810, v3
    v_add_u32 v89, 0x810, v89
    s_waitcnt lgkmcnt(0)
    v_mfma_f32_32x32x16_bf16 v[8:23], v[80:83], v[4:7], 0
    s_nop 11
    v_max_f32 v25, v8, v9
    v_max3_f32 v25, v25, v10, v11
    v_max3_f32 v25, v25, v12, v13
    v_max3_f32 v25, v25, v14, v15
    v_max3_f32 v25, v25, v16, v17
    v_max3_f32 v25, v25, v18, v19
    v_max3_f32 v25, v25, v20, v21
    v_max3_f32 v25, v25, v22, v23
    v_mov_b32 v27, v25
    s_nop 1
    v_permlane32_swap_b32 v25, v27
    v_max3_f32 v25, v25, v27, v24
    v_sub_f32 v26, v24, v25
    v_exp_f32 v26, v26
    v_mov_b32 v24, v25
    v_sub_f32 v8, v8, v25
    v_sub_f32 v9, v9, v25
    v_sub_f32 v10, v10, v25
    v_sub_f32 v11, v11, v25
    v_sub_f32 v12, v12, v25
    v_sub_f32 v13, v13, v25
    v_sub_f32 v14, v14, v25
    v_sub_f32 v15, v15, v25
    v_sub_f32 v16, v16, v25
    v_sub_f32 v17, v17, v25
    v_sub_f32 v18, v18, v25
    v_sub_f32 v19, v19, v25
    v_sub_f32 v20, v20, v25
    v_sub_f32 v21, v21, v25
    v_sub_f32 v22, v22, v25
    v_sub_f32 v23, v23, v25
    v_exp_f32 v8, v8
    v_exp_f32 v9, v9
    v_exp_f32 v10, v10
    v_exp_f32 v11, v11
    v_exp_f32 v12, v12
    v_exp_f32 v13, v13
    v_exp_f32 v14, v14
    v_exp_f32 v15, v15
    v_exp_f32 v16, v16
    v_exp_f32 v17, v17
    v_exp_f32 v18, v18
    v_exp_f32 v19, v19
    v_exp_f32 v20, v20
    v_exp_f32 v21, v21
    v_exp_f32 v22, v22
    v_exp_f32 v23, v23
    v_mul_f32 v40, v40, v26
    v_mul_f32 v41, v41, v26
    v_mul_f32 v42, v42, v26
    v_mul_f32 v43, v43, v26
    v_mul_f32 v44, v44, v26
    v_mul_f32 v45, v45, v26
    v_mul_f32 v46, v46, v26
    v_mul_f32 v47, v47, v26
    v_mul_f32 v48, v48, v26
    v_mul_f32 v49, v49, v26
    v_mul_f32 v50, v50, v26
    v_mul_f32 v51, v51, v26
    v_mul_f32 v52, v52, v26
    v_mul_f32 v53, v53, v26
    v_mul_f32 v54, v54, v26
    v_mul_f32 v55, v55, v26
    v_cvt_pk_bf16_f32 v56, v8, v9
    v_cvt_pk_bf16_f32 v57, v10, v11
    v_cvt_pk_bf16_f32 v58, v12, v13
    v_cvt_pk_bf16_f32 v59, v14, v15
    v_cvt_pk_bf16_f32 v60, v16, v17
    v_cvt_pk_bf16_f32 v61, v18, v19
    v_cvt_pk_bf16_f32 v62, v20, v21
    v_cvt_pk_bf16_f32 v63, v22, v23
    v_mfma_f32_32x32x16_bf16 v[40:55], v[64:67], v[56:59], v[40:55]
    s_nop 0
    v_mfma_f32_32x32x16_bf16 v[40:55], v[68:71], v[60:63], v[40:55]
    s_sub_u32 s62, s62, 1
    s_cmp_lg_u32 s62, 0
    s_nop 7
    s_nop 7
    s_cbranch_scc1 L_attn_slow
    s_mov_b32 s43, 131072
    s_mov_b32 s3, 0x30400
L_poll_12:
    buffer_load_dwordx4 v[192:195], v2, s[36:39], s3 offen sc1
L_pc_14:
    s_waitcnt vmcnt(0)
    v_xor_b32 v192, s100, v192
    v_xor_b32 v193, s100, v193
    v_xor_b32 v194, s100, v194
    v_xor_b32 v195, s100, v195
    v_or3_b32 v192, v192, v193, v194
    v_or_b32 v192, v192, v195
    v_cmp_le_u32 vcc, 16, v192
    s_cbranch_vccz L_pd_13
    s_sub_u32 s43, s43, 1
    s_cmp_lg_u32 s43, 0
    s_sleep 2
    s_cbranch_scc1 L_poll_12
L_pd_13:
    s_lshr_b32 s51, s42, 1
    s_lshl_b32 s51, s51, 3
    s_lshl_b32 s52, s40, 6
    s_add_u32 s51, s51, s52
    s_lshl_b32 s51, s51, 10
    s_add_u32 s51, s51, 0x240000
    s_add_u32 s52, s51, 32768
    buffer_load_dwordx4 v[192:195], v2, s[36:39], s51 offen offset:0 sc1
    buffer_load_dwordx4 v[224:227], v2, s[36:39], s52 offen offset:0 sc1
    buffer_load_dwordx4 v[196:199], v2, s[36:39], s51 offen offset:1024 sc1
    buffer_load_dwordx4 v[228:231], v2, s[36:39], s52 offen offset:1024 sc1
    buffer_load_dwordx4 v[200:203], v2, s[36:39], s51 offen offset:2048 sc1
    buffer_load_dwordx4 v[232:235], v2, s[36:39], s52 offen offset:2048 sc1
    buffer_load_dwordx4 v[204:207], v2, s[36:39], s51 offen offset:3072 sc1
    buffer_load_dwordx4 v[236:239], v2, s[36:39], s52 offen offset:3072 sc1
    s_add_u32 s51, s51, 4096
    buffer_load_dwordx4 v[208:211], v2, s[36:39], s51 offen offset:0 sc1
    s_add_u32 s52, s52, 4096
    buffer_load_dwordx4 v[240:243], v2, s[36:39], s52 offen offset:0 sc1
    buffer_load_dwordx4 v[212:215], v2, s[36:39], s51 offen offset:1024 sc1
    buffer_load_dwordx4 v[244:247], v2, s[36:39], s52 offen offset:1024 sc1
    buffer_load_dwordx4 v[216:219], v2, s[36:39], s51 offen offset:2048 sc1
    buffer_load_dwordx4 v[248:251], v2, s[36:39], s52 offen offset:2048 sc1
    buffer_load_dwordx4 v[220:223], v2, s[36:39], s51 offen offset:3072 sc1
    buffer_load_dwordx4 v[252:255], v2, s[36:39], s52 offen offset:3072 sc1
    s_and_b32 s3, s42, 1
    s_lshl_b32 s43, s41, 1
    s_add_u32 s3, s3, s43
    s_lshl_b32 s3, s3, 15
    s_lshl_b32 s43, s40, 7
    s_add_u32 s3, s3, s43
    s_lshr_b32 s43, s42, 1
    s_lshl_b32 s43, s43, 5
    s_add_u32 s53, s3, s43
    buffer_load_dwordx4 v[92:95], v90, s[4:7], s53 offen
    s_mul_i32 s54, s40, 7
    s_add_u32 s54, s54, s42
    s_lshl_b32 s54, s54, 15
    s_add_u32 s54, s54, 0x2c0000
    s_mul_i32 s55, s40, 224
    s_mul_i32 s43, s42, 14
    s_add_u32 s55, s55, s43
    s_lshl_b32 s55, s55, 10
    s_add_u32 s55, s55, 0x480000
    s_add_u32 s56, s55, 8192
    s_cmp_eq_u32 s42, 7
    s_cselect_b32 s57, s56, s54
    s_cselect_b32 s58, 100352, 0
    buffer_load_dwordx4 v[96:99], v2, s[36:39], s57 offen offset:0 sc1
    buffer_load_dwordx4 v[100:103], v2, s[36:39], s57 offen offset:1024 sc1
    buffer_load_dwordx4 v[104:107], v2, s[36:39], s57 offen offset:2048 sc1
    buffer_load_dwordx4 v[108:111], v2, s[36:39], s57 offen offset:3072 sc1
    s_add_u32 s57, s57, 4096
    buffer_load_dwordx4 v[112:115], v2, s[36:39], s57 offen offset:0 sc1
    buffer_load_dwordx4 v[116:119], v2, s[36:39], s57 offen offset:1024 sc1
    s_add_u32 s57, s57, 2048
    s_add_u32 s57, s57, s58
    buffer_load_dwordx4 v[120:123], v2, s[36:39], s57 offen offset:0 sc1
    buffer_load_dwordx4 v[124:127], v2, s[36:39], s57 offen offset:1024 sc1
    buffer_load_dwordx4 v[128:131], v2, s[36:39], s57 offen offset:2048 sc1
    buffer_load_dwordx4 v[132:135], v2, s[36:39], s57 offen offset:3072 sc1
    s_add_u32 s57, s57, 4096
    buffer_load_dwordx4 v[136:139], v2, s[36:39], s57 offen offset:0 sc1
    buffer_load_dwordx4 v[140:143], v2, s[36:39], s57 offen offset:1024 sc1
    buffer_load_dwordx4 v[144:147], v2, s[36:39], s57 offen offset:2048 sc1
    buffer_load_dwordx4 v[148:151], v2, s[36:39], s57 offen offset:3072 sc1
    s_add_u32 s57, s57, 4096
    buffer_load_dwordx4 v[152:155], v2, s[36:39], s57 offen offset:0 sc1
    buffer_load_dwordx4 v[156:159], v2, s[36:39], s57 offen offset:1024 sc1
    buffer_load_dwordx4 v[160:163], v2, s[36:39], s57 offen offset:2048 sc1
    buffer_load_dwordx4 v[164:167], v2, s[36:39], s57 offen offset:3072 sc1
    s_add_u32 s57, s57, 4096
    buffer_load_dwordx4 v[168:171], v2, s[36:39], s57 offen offset:0 sc1
    buffer_load_dwordx4 v[172:175], v2, s[36:39], s57 offen offset:1024 sc1
    buffer_load_dwordx4 v[176:179], v2, s[36:39], s57 offen offset:2048 sc1
    buffer_load_dwordx4 v[180:183], v2, s[36:39], s57 offen offset:3072 sc1
    s_add_u32 s57, s57, 4096
    buffer_load_dwordx4 v[184:187], v2, s[36:39], s57 offen offset:0 sc1
    buffer_load_dwordx4 v[188:191], v2, s[36:39], s57 offen offset:1024 sc1
L_attn_fin:
    s_nop 11
    v_rcp_f32 v8, v48
    s_nop 0
    v_mul_f32 v40, v40, v8
    v_mul_f32 v41, v41, v8
    v_mul_f32 v42, v42, v8
    v_mul_f32 v43, v43, v8
    v_mul_f32 v44, v44, v8
    v_mul_f32 v45, v45, v8
    v_mul_f32 v46, v46, v8
    v_mul_f32 v47, v47, v8
    v_cvt_pk_bf16_f32 v40, v40, v41
    v_cvt_pk_bf16_f32 v41, v42, v43
    v_cvt_pk_bf16_f32 v42, v44, v45
    v_cvt_pk_bf16_f32 v43, v46, v47
    s_lshl_b32 s3, s41, 1
    s_add_u32 s3, s3, s49
    s_lshl_b32 s3, s3, 3
    s_add_u32 s3, s3, s40
    s_lshl_b32 s3, s3, 1
    s_add_u32 s3, s3, s48
    s_lshl_b32 s3, s3, 1
    s_add_u32 s3, s3, s50
    s_lshl_b32 s3, s3, 10
    s_add_u32 s3, s3, 0x640000
    s_cmp_eq_u32 s101, 0
    s_cbranch_scc1 L_sl_15
    buffer_store_dwordx4 v[40:43], v2, s[36:39], s3 offen
    s_branch L_dn_16
L_sl_15:
    buffer_store_dwordx4 v[40:43], v2, s[36:39], s3 offen sc1
L_dn_16:
    s_lshl_b32 s3, s41, 1
    s_add_u32 s3, s3, s49
    s_lshl_b32 s3, s3, 3
    s_add_u32 s3, s3, s40
    s_lshl_b32 s3, s3, 1
    s_add_u32 s3, s3, s50
    s_lshl_b32 s3, s3, 1
    s_add_u32 s3, s3, s48
    s_lshl_b32 s3, s3, 2
    s_add_u32 s3, s3, 0x31000
    s_waitcnt vmcnt(0)
    s_cmp_eq_u32 s101, 0
    s_cbranch_scc1 L_sl_17
    v_mov_b32 v8, s100
    s_mov_b64 exec, 1
    buffer_store_dword v8, off, s[36:39], s3
    s_mov_b64 exec, -1
    s_branch L_dn_18
L_sl_17:
    v_mov_b32 v8, s100
    s_mov_b64 exec, 1
    buffer_store_dword v8, off, s[36:39], s3 sc1
    s_mov_b64 exec, -1
L_dn_18:
    s_and_b32 s48, s42, 1
    s_lshr_b32 s49, s42, 1
    s_mov_b32 s44, 0x3f803f80
    s_cmp_eq_u32 s42, 7
    s_cbranch_scc1 L_cs_skip
    v_dot2_f32_bf16 v80, v96, s44, 0
    v_dot2_f32_bf16 v81, v97, s44, 0
    v_dot2_f32_bf16 v82, v98, s44, 0
    v_dot2_f32_bf16 v83, v99, s44, 0
    v_dot2_f32_bf16 v80, v100, s44, v80
    v_dot2_f32_bf16 v81, v101, s44, v81
    v_dot2_f32_bf16 v82, v102, s44, v82
    v_dot2_f32_bf16 v83, v103, s44, v83
    v_dot2_f32_bf16 v80, v104, s44, v80
    v_dot2_f32_bf16 v81, v105, s44, v81
    v_dot2_f32_bf16 v82, v106, s44, v82
    v_dot2_f32_bf16 v83, v107, s44, v83
    v_dot2_f32_bf16 v80, v108, s44, v80
    v_dot2_f32_bf16 v81, v109, s44, v81
    v_dot2_f32_bf16 v82, v110, s44, v82
    v_dot2_f32_bf16 v83, v111, s44, v83
    v_dot2_f32_bf16 v80, v112, s44, v80
    v_dot2_f32_bf16 v81, v113, s44, v81
    v_dot2_f32_bf16 v82, v114, s44, v82
    v_dot2_f32_bf16 v83, v115, s44, v83
    v_dot2_f32_bf16 v80, v116, s44, v80
    v_dot2_f32_bf16 v81, v117, s44, v81
    v_dot2_f32_bf16 v82, v118, s44, v82
    v_dot2_f32_bf16 v83, v119, s44, v83
    v_dot2_f32_bf16 v80, v120, s44, v80
    v_dot2_f32_bf16 v81, v121, s44, v81
    v_dot2_f32_bf16 v82, v122, s44, v82
    v_dot2_f32_bf16 v83, v123, s44, v83
    v_dot2_f32_bf16 v80, v124, s44, v80
    v_dot2_f32_bf16 v81, v125, s44, v81
    v_dot2_f32_bf16 v82, v126, s44, v82
    v_dot2_f32_bf16 v83, v127, s44, v83
    v_dot2_f32_bf16 v80, v128, s44, v80
    v_dot2_f32_bf16 v81, v129, s44, v81
    v_dot2_f32_bf16 v82, v130, s44, v82
    v_dot2_f32_bf16 v83, v131, s44, v83
    v_dot2_f32_bf16 v80, v132, s44, v80
    v_dot2_f32_bf16 v81, v133, s44, v81
    v_dot2_f32_bf16 v82, v134, s44, v82
    v_dot2_f32_bf16 v83, v135, s44, v83
    v_dot2_f32_bf16 v80, v136, s44, v80
    v_dot2_f32_bf16 v81, v137, s44, v81
    v_dot2_f32_bf16 v82, v138, s44, v82
    v_dot2_f32_bf16 v83, v139, s44, v83
    v_dot2_f32_bf16 v80, v140, s44, v80
    v_dot2_f32_bf16 v81, v141, s44, v81
    v_dot2_f32_bf16 v82, v142, s44, v82
    v_dot2_f32_bf16 v83, v143, s44, v83
    v_dot2_f32_bf16 v80, v144, s44, v80
    v_dot2_f32_bf16 v81, v145, s44, v81
    v_dot2_f32_bf16 v82, v146, s44, v82
    v_dot2_f32_bf16 v83, v147, s44, v83
    v_dot2_f32_bf16 v80, v148, s44, v80
    v_dot2_f32_bf16 v81, v149, s44, v81
    v_dot2_f32_bf16 v82, v150, s44, v82
    v_dot2_f32_bf16 v83, v151, s44, v83
    v_dot2_f32_bf16 v80, v152, s44, v80
    v_dot2_f32_bf16 v81, v153, s44, v81
    v_dot2_f32_bf16 v82, v154, s44, v82
    v_dot2_f32_bf16 v83, v155, s44, v83
    v_dot2_f32_bf16 v80, v156, s44, v80
    v_dot2_f32_bf16 v81, v157, s44, v81
    v_dot2_f32_bf16 v82, v158, s44, v82
    v_dot2_f32_bf16 v83, v159, s44, v83
    v_dot2_f32_bf16 v80, v160, s44, v80
    v_dot2_f32_bf16 v81, v161, s44, v81
    v_dot2_f32_bf16 v82, v162, s44, v82
    v_dot2_f32_bf16 v83, v163, s44, v83
    v_dot2_f32_bf16 v80, v164, s44, v80
    v_dot2_f32_bf16 v81, v165, s44, v81
    v_dot2_f32_bf16 v82, v166, s44, v82
    v_dot2_f32_bf16 v83, v167, s44, v83
    v_dot2_f32_bf16 v80, v168, s44, v80
    v_dot2_f32_bf16 v81, v169, s44, v81
    v_dot2_f32_bf16 v82, v170, s44, v82
    v_dot2_f32_bf16 v83, v171, s44, v83
    v_dot2_f32_bf16 v80, v172, s44, v80
    v_dot2_f32_bf16 v81, v173, s44, v81
    v_dot2_f32_bf16 v82, v174, s44, v82
    v_dot2_f32_bf16 v83, v175, s44, v83
    v_dot2_f32_bf16 v80, v176, s44, v80
    v_dot2_f32_bf16 v81, v177, s44, v81
    v_dot2_f32_bf16 v82, v178, s44, v82
    v_dot2_f32_bf16 v83, v179, s44, v83
    v_dot2_f32_bf16 v80, v180, s44, v80
    v_dot2_f32_bf16 v81, v181, s44, v81
    v_dot2_f32_bf16 v82, v182, s44, v82
    v_dot2_f32_bf16 v83, v183, s44, v83
    v_dot2_f32_bf16 v80, v184, s44, v80
    v_dot2_f32_bf16 v81, v185, s44, v81
    v_dot2_f32_bf16 v82, v186, s44, v82
    v_dot2_f32_bf16 v83, v187, s44, v83
    v_dot2_f32_bf16 v80, v188, s44, v80
    v_dot2_f32_bf16 v81, v189, s44, v81
    v_dot2_f32_bf16 v82, v190, s44, v82
    v_dot2_f32_bf16 v83, v191, s44, v83
L_cs_skip:
    s_lshl_b32 s3, s41, 1
    s_add_u32 s3, s3, s48
    s_lshl_b32 s50, s3, 5
    s_lshl_b32 s3, s49, 3
    s_add_u32 s3, s3, s50
    s_lshl_b32 s18, s3, 10
    s_add_u32 s18, s18, 0x640000
    s_lshl_b32 s3, s3, 2
    s_add_u32 s3, s3, 0x31000
    v_and_b32 v73, 7, v1
    v_lshlrev_b32 v73, 2, v73
    s_mov_b32 s43, 131072
L_poll_19:
    buffer_load_dword v72, v73, s[36:39], s3 offen sc1
    s_waitcnt vmcnt(0)
    v_cmp_ne_u32 vcc, s100, v72
    s_cbranch_vccz L_pd_20
    s_sub_u32 s43, s43, 1
    s_cmp_lg_u32 s43, 0
    s_cbranch_scc1 L_poll_19
L_pd_20:
    buffer_load_dwordx4 v[8:11], v2, s[36:39], s18 offen offset:0 sc1
    buffer_load_dwordx4 v[12:15], v2, s[36:39], s18 offen offset:1024 sc1
    buffer_load_dwordx4 v[16:19], v2, s[36:39], s18 offen offset:2048 sc1
    buffer_load_dwordx4 v[20:23], v2, s[36:39], s18 offen offset:3072 sc1
    s_add_u32 s18, s18, 4096
    buffer_load_dwordx4 v[24:27], v2, s[36:39], s18 offen offset:0 sc1
    buffer_load_dwordx4 v[28:31], v2, s[36:39], s18 offen offset:1024 sc1
    buffer_load_dwordx4 v[32:35], v2, s[36:39], s18 offen offset:2048 sc1
    buffer_load_dwordx4 v[36:39], v2, s[36:39], s18 offen offset:3072 sc1
    s_waitcnt vmcnt(7)
    v_mfma_f32_32x32x16_bf16 v[40:55], v[192:195], v[8:11], 0
    v_mfma_f32_32x32x16_bf16 v[64:79], v[224:227], v[8:11], 0
    s_waitcnt vmcnt(6)
    v_mfma_f32_32x32x16_bf16 v[40:55], v[196:199], v[12:15], v[40:55]
    v_mfma_f32_32x32x16_bf16 v[64:79], v[228:231], v[12:15], v[64:79]
    s_waitcnt vmcnt(5)
    v_mfma_f32_32x32x16_bf16 v[40:55], v[200:203], v[16:19], v[40:55]
    v_mfma_f32_32x32x16_bf16 v[64:79], v[232:235], v[16:19], v[64:79]
    s_waitcnt vmcnt(4)
    v_mfma_f32_32x32x16_bf16 v[40:55], v[204:207], v[20:23], v[40:55]
    v_mfma_f32_32x32x16_bf16 v[64:79], v[236:239], v[20:23], v[64:79]
    s_waitcnt vmcnt(3)
    v_mfma_f32_32x32x16_bf16 v[40:55], v[208:211], v[24:27], v[40:55]
    v_mfma_f32_32x32x16_bf16 v[64:79], v[240:243], v[24:27], v[64:79]
    s_waitcnt vmcnt(2)
    v_mfma_f32_32x32x16_bf16 v[40:55], v[212:215], v[28:31], v[40:55]
    v_mfma_f32_32x32x16_bf16 v[64:79], v[244:247], v[28:31], v[64:79]
    s_waitcnt vmcnt(1)
    v_mfma_f32_32x32x16_bf16 v[40:55], v[216:219], v[32:35], v[40:55]
    v_mfma_f32_32x32x16_bf16 v[64:79], v[248:251], v[32:35], v[64:79]
    s_waitcnt vmcnt(0)
    v_mfma_f32_32x32x16_bf16 v[40:55], v[220:223], v[36:39], v[40:55]
    v_mfma_f32_32x32x16_bf16 v[64:79], v[252:255], v[36:39], v[64:79]
    s_barrier
    s_lshl_b32 s3, s48, 15
    s_lshl_b32 s43, s49, 11
    s_add_u32 s3, s3, s43
    v_add_u32 v84, s3, v2
    s_nop 7
    s_cmp_eq_u32 s49, 0
    s_cbranch_scc1 L_o_skip0
    ds_write_b128 v84, v[40:43] offset:0
    ds_write_b128 v84, v[44:47] offset:1024
    s_branch L_o_nxt0
L_o_skip0:
    v_mov_b32 v56, v40
    v_mov_b32 v57, v41
    v_mov_b32 v58, v42
    v_mov_b32 v59, v43
    v_mov_b32 v60, v44
    v_mov_b32 v61, v45
    v_mov_b32 v62, v46
    v_mov_b32 v63, v47
L_o_nxt0:
    s_cmp_eq_u32 s49, 1
    s_cbranch_scc1 L_o_skip1
    ds_write_b128 v84, v[48:51] offset:8192
    ds_write_b128 v84, v[52:55] offset:9216
    s_branch L_o_nxt1
L_o_skip1:
    v_mov_b32 v56, v48
    v_mov_b32 v57, v49
    v_mov_b32 v58, v50
    v_mov_b32 v59, v51
    v_mov_b32 v60, v52
    v_mov_b32 v61, v53
    v_mov_b32 v62, v54
    v_mov_b32 v63, v55
L_o_nxt1:
    s_cmp_eq_u32 s49, 2
    s_cbranch_scc1 L_o_skip2
    ds_write_b128 v84, v[64:67] offset:16384
    ds_write_b128 v84, v[68:71] offset:17408
    s_branch L_o_nxt2
L_o_skip2:
    v_mov_b32 v56, v64
    v_mov_b32 v57, v65
    v_mov_b32 v58, v66
    v_mov_b32 v59, v67
    v_mov_b32 v60, v68
    v_mov_b32 v61, v69
    v_mov_b32 v62, v70
    v_mov_b32 v63, v71
L_o_nxt2:
    s_cmp_eq_u32 s49, 3
    s_cbranch_scc1 L_o_skip3
    ds_write_b128 v84, v[72:75] offset:24576
    ds_write_b128 v84, v[76:79] offset:25600
    s_branch L_o_nxt3
L_o_skip3:
    v_mov_b32 v56, v72
    v_mov_b32 v57, v73
    v_mov_b32 v58, v74
    v_mov_b32 v59, v75
    v_mov_b32 v60, v76
    v_mov_b32 v61, v77
    v_mov_b32 v62, v78
    v_mov_b32 v63, v79
L_o_nxt3:
    s_waitcnt lgkmcnt(0)
    s_barrier
    s_lshl_b32 s3, s48, 15
    s_lshl_b32 s43, s49, 13
    s_add_u32 s3, s3, s43
    s_add_u32 s43, s49, 1
    s_and_b32 s43, s43, 3
    s_lshl_b32 s43, s43, 11
    s_add_u32 s43, s43, s3
    v_add_u32 v84, s43, v2
    ds_read_b128 v[8:11], v84
    ds_read_b128 v[12:15], v84 offset:1024
    s_add_u32 s43, s49, 2
    s_and_b32 s43, s43, 3
    s_lshl_b32 s43, s43, 11
    s_add_u32 s43, s43, s3
    v_add_u32 v85, s43, v2
    ds_read_b128 v[16:19], v85
    ds_read_b128 v[20:23], v85 offset:1024
    s_add_u32 s43, s49, 3
    s_and_b32 s43, s43, 3
    s_lshl_b32 s43, s43, 11
    s_add_u32 s43, s43, s3
    v_add_u32 v86, s43, v2
    ds_read_b128 v[24:27], v86
    ds_read_b128 v[28:31], v86 offset:1024
    v_permlane32_swap_b32 v92, v94
    v_permlane32_swap_b32 v93, v95
    v_lshlrev_b32 v32, 16, v92
    v_and_b32 v33, 0xffff0000, v92
    v_lshlrev_b32 v34, 16, v93
    v_and_b32 v35, 0xffff0000, v93
    v_lshlrev_b32 v36, 16, v94
    v_and_b32 v37, 0xffff0000, v94
    v_lshlrev_b32 v38, 16, v95
    v_and_b32 v39, 0xffff0000, v95
    s_waitcnt lgkmcnt(0)
    v_add_f32 v56, v56, v8
    v_add_f32 v16, v16, v24
    v_add_f32 v57, v57, v9
    v_add_f32 v17, v17, v25
    v_add_f32 v58, v58, v10
    v_add_f32 v18, v18, v26
    v_add_f32 v59, v59, v11
    v_add_f32 v19, v19, v27
    v_add_f32 v60, v60, v12
    v_add_f32 v20, v20, v28
    v_add_f32 v61, v61, v13
    v_add_f32 v21, v21, v29
    v_add_f32 v62, v62, v14
    v_add_f32 v22, v22, v30
    v_add_f32 v63, v63, v15
    v_add_f32 v23, v23, v31
    v_add_f32 v56, v56, v16
    v_add_f32 v57, v57, v17
    v_add_f32 v58, v58, v18
    v_add_f32 v59, v59, v19
    v_add_f32 v60, v60, v20
    v_add_f32 v61, v61, v21
    v_add_f32 v62, v62, v22
    v_add_f32 v63, v63, v23
    v_add_f32 v56, v56, v32
    v_add_f32 v57, v57, v33
    v_add_f32 v58, v58, v34
    v_add_f32 v59, v59, v35
    v_add_f32 v60, v60, v36
    v_add_f32 v61, v61, v37
    v_add_f32 v62, v62, v38
    v_add_f32 v63, v63, v39
    v_cvt_pk_bf16_f32 v4, v56, v57
    v_cvt_pk_bf16_f32 v5, v58, v59
    v_cvt_pk_bf16_f32 v6, v60, v61
    v_cvt_pk_bf16_f32 v7, v62, v63
    s_lshl_b32 s3, s40, 2
    s_add_u32 s3, s3, s49
    s_add_u32 s3, s3, s50
    s_lshl_b32 s3, s3, 10
    s_add_u32 s3, s3, 0x840000
    s_cmp_eq_u32 s101, 0
    s_cbranch_scc1 L_sl_21
    buffer_store_dwordx4 v[4:7], v2, s[36:39], s3 offen
    s_branch L_dn_22
L_sl_21:
    buffer_store_dwordx4 v[4:7], v2, s[36:39], s3 offen sc1
L_dn_22:
    s_lshl_b32 s3, s41, 3
    s_add_u32 s3, s3, s40
    s_lshl_b32 s3, s3, 3
    s_add_u32 s3, s3, s42
    s_lshl_b32 s3, s3, 2
    s_add_u32 s3, s3, 0x33000
    s_waitcnt vmcnt(0)
    s_cmp_eq_u32 s101, 0
    s_cbranch_scc1 L_sl_23
    v_mov_b32 v72, s100
    s_mov_b64 exec, 1
    buffer_store_dword v72, off, s[36:39], s3
    s_mov_b64 exec, -1
    s_branch L_dn_24
L_sl_23:
    v_mov_b32 v72, s100
    s_mov_b64 exec, 1
    buffer_store_dword v72, off, s[36:39], s3 sc1
    s_mov_b64 exec, -1
L_dn_24:
    s_mul_i32 s55, s40, 224
    s_mul_i32 s43, s42, 14
    s_add_u32 s55, s55, s43
    s_lshl_b32 s55, s55, 10
    s_add_u32 s55, s55, 0x480000
    s_add_u32 s56, s55, 114688
    s_cmp_eq_u32 s42, 7
    s_cbranch_scc1 L_g1_now1
    s_add_u32 s54, s54, 24576
    buffer_load_dwordx4 v[192:195], v2, s[36:39], s54 offen offset:0 sc1
    buffer_load_dwordx4 v[196:199], v2, s[36:39], s54 offen offset:1024 sc1
    buffer_load_dwordx4 v[200:203], v2, s[36:39], s54 offen offset:2048 sc1
    buffer_load_dwordx4 v[204:207], v2, s[36:39], s54 offen offset:3072 sc1
    s_add_u32 s54, s54, 4096
    buffer_load_dwordx4 v[208:211], v2, s[36:39], s54 offen offset:0 sc1
    buffer_load_dwordx4 v[212:215], v2, s[36:39], s54 offen offset:1024 sc1
    buffer_load_dwordx4 v[216:219], v2, s[36:39], s54 offen offset:2048 sc1
    buffer_load_dwordx4 v[220:223], v2, s[36:39], s54 offen offset:3072 sc1
    s_mul_i32 s48, s40, 7
    s_add_u32 s48, s48, s42
    v_lshrrev_b32 v3, 5, v1
    v_lshlrev_b32 v3, 3, v3
    s_lshl_b32 s50, s48, 6
    buffer_load_dwordx2 v[64:65], v3, s[24:27], s50 offen offset:0
    buffer_load_dwordx2 v[66:67], v3, s[24:27], s50 offen offset:16
    buffer_load_dwordx2 v[68:69], v3, s[24:27], s50 offen offset:32
    buffer_load_dwordx2 v[70:71], v3, s[24:27], s50 offen offset:48
L_g1_now1:
    s_lshl_b32 s3, s41, 3
    s_add_u32 s3, s3, s42
    s_lshl_b32 s3, s3, 5
    s_add_u32 s3, s3, 0x33000
    v_and_b32 v73, 7, v1
    v_lshlrev_b32 v73, 2, v73
    s_mov_b32 s43, 131072
L_poll_25:
    buffer_load_dword v72, v73, s[36:39], s3 offen sc1
    s_waitcnt vmcnt(0)
    v_cmp_ne_u32 vcc, s100, v72
    s_cbranch_vccz L_pd_26
    s_sub_u32 s43, s43, 1
    s_cmp_lg_u32 s43, 0
    s_cbranch_scc1 L_poll_25
L_pd_26:
    s_lshl_b32 s43, s41, 16
    s_lshl_b32 s3, s42, 12
    s_add_u32 s43, s43, s3
    s_add_u32 s43, s43, 0x840000
    s_add_u32 s3, s3, 65536
    s_mov_b32 m0, s3
    s_nop 0
    buffer_load_dwordx4 v2, s[36:39], s43 offen offset:0 sc1 lds
    buffer_load_dwordx4 v2, s[36:39], s43 offen offset:1024 sc1 lds
    buffer_load_dwordx4 v2, s[36:39], s43 offen offset:2048 sc1 lds
    buffer_load_dwordx4 v2, s[36:39], s43 offen offset:3072 sc1 lds
    s_add_u32 s3, s3, 32768
    s_add_u32 s43, s43, 32768
    s_mov_b32 m0, s3
    s_nop 0
    buffer_load_dwordx4 v2, s[36:39], s43 offen offset:0 sc1 lds
    buffer_load_dwordx4 v2, s[36:39], s43 offen offset:1024 sc1 lds
    buffer_load_dwordx4 v2, s[36:39], s43 offen offset:2048 sc1 lds
    buffer_load_dwordx4 v2, s[36:39], s43 offen offset:3072 sc1 lds
    s_cmp_eq_u32 s42, 7
    s_cbranch_scc1 L_g1_stats
    s_waitcnt vmcnt(0)
    s_barrier
    v_add_u32 v92, 65536, v2
    ds_read_b128 v[8:11], v92 offset:0
    ds_read_b128 v[12:15], v92 offset:32768
    ds_read_b128 v[16:19], v92 offset:1024
    ds_read_b128 v[20:23], v92 offset:33792
    ds_read_b128 v[24:27], v92 offset:2048
    ds_read_b128 v[28:31], v92 offset:34816
    s_waitcnt lgkmcnt(5)
    v_mfma_f32_32x32x16_bf16 v[32:47], v[96:99], v[8:11], 0
    ds_read_b128 v[8:11], v92 offset:3072
    s_waitcnt lgkmcnt(5)
    v_mfma_f32_32x32x16_bf16 v[48:63], v[96:99], v[12:15], 0
    buffer_load_dwordx4 v[224:227], v2, s[36:39], s55 offen offset:0 sc1
    ds_read_b128 v[12:15], v92 offset:35840
    s_waitcnt lgkmcnt(5)
    v_mfma_f32_32x32x16_bf16 v[32:47], v[100:103], v[16:19], v[32:47]
    ds_read_b128 v[16:19], v92 offset:4096
    s_waitcnt lgkmcnt(5)
    v_mfma_f32_32x32x16_bf16 v[48:63], v[100:103], v[20:23], v[48:63]
    buffer_load_dwordx4 v[228:231], v2, s[36:39], s55 offen offset:1024 sc1
    ds_read_b128 v[20:23], v92 offset:36864
    s_waitcnt lgkmcnt(5)
    v_mfma_f32_32x32x16_bf16 v[32:47], v[104:107], v[24:27], v[32:47]
    ds_read_b128 v[24:27], v92 offset:5120
    s_waitcnt lgkmcnt(5)
    v_mfma_f32_32x32x16_bf16 v[48:63], v[104:107], v[28:31], v[48:63]
    buffer_load_dwordx4 v[232:235], v2, s[36:39], s55 offen offset:2048 sc1
    ds_read_b128 v[28:31], v92 offset:37888
    s_waitcnt lgkmcnt(5)
    v_mfma_f32_32x32x16_bf16 v[32:47], v[108:111], v[8:11], v[32:47]
    ds_read_b128 v[8:11], v92 offset:6144
    s_waitcnt lgkmcnt(5)
    v_mfma_f32_32x32x16_bf16 v[48:63], v[108:111], v[12:15], v[48:63]
    buffer_load_dwordx4 v[236:239], v2, s[36:39], s55 offen offset:3072 sc1
    ds_read_b128 v[12:15], v92 offset:38912
    s_waitcnt lgkmcnt(5)
    v_mfma_f32_32x32x16_bf16 v[32:47], v[112:115], v[16:19], v[32:47]
    ds_read_b128 v[16:19], v92 offset:7168
    s_waitcnt lgkmcnt(5)
    v_mfma_f32_32x32x16_bf16 v[48:63], v[112:115], v[20:23], v[48:63]
    s_add_u32 s57, s55, 4096
    buffer_load_dwordx4 v[240:243], v2, s[36:39], s57 offen offset:0 sc1
    ds_read_b128 v[20:23], v92 offset:39936
    s_waitcnt lgkmcnt(5)
    v_mfma_f32_32x32x16_bf16 v[32:47], v[116:119], v[24:27], v[32:47]
    ds_read_b128 v[24:27], v92 offset:8192
    s_waitcnt lgkmcnt(5)
    v_mfma_f32_32x32x16_bf16 v[48:63], v[116:119], v[28:31], v[48:63]
    s_add_u32 s57, s55, 4096
    buffer_load_dwordx4 v[244:247], v2, s[36:39], s57 offen offset:1024 sc1
    ds_read_b128 v[28:31], v92 offset:40960
    s_waitcnt lgkmcnt(5)
    v_mfma_f32_32x32x16_bf16 v[32:47], v[120:123], v[8:11], v[32:47]
    ds_read_b128 v[8:11], v92 offset:9216
    s_waitcnt lgkmcnt(5)
    v_mfma_f32_32x32x16_bf16 v[48:63], v[120:123], v[12:15], v[48:63]
    s_add_u32 s57, s55, 4096
    buffer_load_dwordx4 v[248:251], v2, s[36:39], s57 offen offset:2048 sc1
    ds_read_b128 v[12:15], v92 offset:41984
    s_waitcnt lgkmcnt(5)
    v_mfma_f32_32x32x16_bf16 v[32:47], v[124:127], v[16:19], v[32:47]
    ds_read_b128 v[16:19], v92 offset:10240
    s_waitcnt lgkmcnt(5)
    v_mfma_f32_32x32x16_bf16 v[48:63], v[124:127], v[20:23], v[48:63]
    s_add_u32 s57, s55, 4096
    buffer_load_dwordx4 v[252:255], v2, s[36:39], s57 offen offset:3072 sc1
    ds_read_b128 v[20:23], v92 offset:43008
    s_waitcnt lgkmcnt(5)
    v_mfma_f32_32x32x16_bf16 v[32:47], v[128:131], v[24:27], v[32:47]
    ds_read_b128 v[24:27], v92 offset:11264
    s_waitcnt lgkmcnt(5)
    v_mfma_f32_32x32x16_bf16 v[48:63], v[128:131], v[28:31], v[48:63]
    s_add_u32 s57, s55, 8192
    buffer_load_dwordx4 v[96:99], v2, s[36:39], s57 offen offset:0 sc1
    ds_read_b128 v[28:31], v92 offset:44032
    s_waitcnt lgkmcnt(5)
    v_mfma_f32_32x32x16_bf16 v[32:47], v[132:135], v[8:11], v[32:47]
    ds_read_b128 v[8:11], v92 offset:12288
    s_waitcnt lgkmcnt(5)
    v_mfma_f32_32x32x16_bf16 v[48:63], v[132:135], v[12:15], v[48:63]
    s_add_u32 s57, s55, 8192
    buffer_load_dwordx4 v[100:103], v2, s[36:39], s57 offen offset:1024 sc1
    ds_read_b128 v[12:15], v92 offset:45056
    s_waitcnt lgkmcnt(5)
    v_mfma_f32_32x32x16_bf16 v[32:47], v[136:139], v[16:19], v[32:47]
    ds_read_b128 v[16:19], v92 offset:13312
    s_waitcnt lgkmcnt(5)
    v_mfma_f32_32x32x16_bf16 v[48:63], v[136:139], v[20:23], v[48:63]
    s_add_u32 s57, s55, 8192
    buffer_load_dwordx4 v[104:107], v2, s[36:39], s57 offen offset:2048 sc1
    ds_read_b128 v[20:23], v92 offset:46080
    s_waitcnt lgkmcnt(5)
    v_mfma_f32_32x32x16_bf16 v[32:47], v[140:143], v[24:27], v[32:47]
    ds_read_b128 v[24:27], v92 offset:14336
    s_waitcnt lgkmcnt(5)
    v_mfma_f32_32x32x16_bf16 v[48:63], v[140:143], v[28:31], v[48:63]
    s_add_u32 s57, s55, 8192
    buffer_load_dwordx4 v[108:111], v2, s[36:39], s57 offen offset:3072 sc1
    ds_read_b128 v[28:31], v92 offset:47104
    s_waitcnt lgkmcnt(5)
    v_mfma_f32_32x32x16_bf16 v[32:47], v[144:147], v[8:11], v[32:47]
    ds_read_b128 v[8:11], v92 offset:15360
    s_waitcnt lgkmcnt(5)
    v_mfma_f32_32x32x16_bf16 v[48:63], v[144:147], v[12:15], v[48:63]
    s_add_u32 s57, s55, 12288
    buffer_load_dwordx4 v[112:115], v2, s[36:39], s57 offen offset:0 sc1
    ds_read_b128 v[12:15], v92 offset:48128
    s_waitcnt lgkmcnt(5)
    v_mfma_f32_32x32x16_bf16 v[32:47], v[148:151], v[16:19], v[32:47]
    ds_read_b128 v[16:19], v92 offset:16384
    s_waitcnt lgkmcnt(5)
    v_mfma_f32_32x32x16_bf16 v[48:63], v[148:151], v[20:23], v[48:63]
    s_add_u32 s57, s55, 12288
    buffer_load_dwordx4 v[116:119], v2, s[36:39], s57 offen offset:1024 sc1
    ds_read_b128 v[20:23], v92 offset:49152
    s_waitcnt lgkmcnt(5)
    v_mfma_f32_32x32x16_bf16 v[32:47], v[152:155], v[24:27], v[32:47]
    ds_read_b128 v[24:27], v92 offset:17408
    s_waitcnt lgkmcnt(5)
    v_mfma_f32_32x32x16_bf16 v[48:63], v[152:155], v[28:31], v[48:63]
    buffer_load_dwordx4 v[120:123], v2, s[36:39], s56 offen offset:0 sc1
    ds_read_b128 v[28:31], v92 offset:50176
    s_waitcnt lgkmcnt(5)
    v_mfma_f32_32x32x16_bf16 v[32:47], v[156:159], v[8:11], v[32:47]
    ds_read_b128 v[8:11], v92 offset:18432
    s_waitcnt lgkmcnt(5)
    v_mfma_f32_32x32x16_bf16 v[48:63], v[156:159], v[12:15], v[48:63]
    buffer_load_dwordx4 v[124:127], v2, s[36:39], s56 offen offset:1024 sc1
    ds_read_b128 v[12:15], v92 offset:51200
    s_waitcnt lgkmcnt(5)
    v_mfma_f32_32x32x16_bf16 v[32:47], v[160:163], v[16:19], v[32:47]
    ds_read_b128 v[16:19], v92 offset:19456
    s_waitcnt lgkmcnt(5)
    v_mfma_f32_32x32x16_bf16 v[48:63], v[160:163], v[20:23], v[48:63]
    buffer_load_dwordx4 v[128:131], v2, s[36:39], s56 offen offset:2048 sc1
    ds_read_b128 v[20:23], v92 offset:52224
    s_waitcnt lgkmcnt(5)
    v_mfma_f32_32x32x16_bf16 v[32:47], v[164:167], v[24:27], v[32:47]
    ds_read_b128 v[24:27], v92 offset:20480
    s_waitcnt lgkmcnt(5)
    v_mfma_f32_32x32x16_bf16 v[48:63], v[164:167], v[28:31], v[48:63]
    buffer_load_dwordx4 v[132:135], v2, s[36:39], s56 offen offset:3072 sc1
    ds_read_b128 v[28:31], v92 offset:53248
    s_waitcnt lgkmcnt(5)
    v_mfma_f32_32x32x16_bf16 v[32:47], v[168:171], v[8:11], v[32:47]
    ds_read_b128 v[8:11], v92 offset:21504
    s_waitcnt lgkmcnt(5)
    v_mfma_f32_32x32x16_bf16 v[48:63], v[168:171], v[12:15], v[48:63]
    s_add_u32 s57, s56, 4096
    buffer_load_dwordx4 v[136:139], v2, s[36:39], s57 offen offset:0 sc1
    ds_read_b128 v[12:15], v92 offset:54272
    s_waitcnt lgkmcnt(5)
    v_mfma_f32_32x32x16_bf16 v[32:47], v[172:175], v[16:19], v[32:47]
    ds_read_b128 v[16:19], v92 offset:22528
    s_waitcnt lgkmcnt(5)
    v_mfma_f32_32x32x16_bf16 v[48:63], v[172:175], v[20:23], v[48:63]
    s_add_u32 s57, s56, 4096
    buffer_load_dwordx4 v[140:143], v2, s[36:39], s57 offen offset:1024 sc1
    ds_read_b128 v[20:23], v92 offset:55296
    s_waitcnt lgkmcnt(5)
    v_mfma_f32_32x32x16_bf16 v[32:47], v[176:179], v[24:27], v[32:47]
    ds_read_b128 v[24:27], v92 offset:23552
    s_waitcnt lgkmcnt(5)
    v_mfma_f32_32x32x16_bf16 v[48:63], v[176:179], v[28:31], v[48:63]
    s_add_u32 s57, s56, 4096
    buffer_load_dwordx4 v[144:147], v2, s[36:39], s57 offen offset:2048 sc1
    ds_read_b128 v[28:31], v92 offset:56320
    s_waitcnt lgkmcnt(5)
    v_mfma_f32_32x32x16_bf16 v[32:47], v[180:183], v[8:11], v[32:47]
    ds_read_b128 v[8:11], v92 offset:24576
    s_waitcnt lgkmcnt(5)
    v_mfma_f32_32x32x16_bf16 v[48:63], v[180:183], v[12:15], v[48:63]
    s_add_u32 s57, s56, 4096
    buffer_load_dwordx4 v[148:151], v2, s[36:39], s57 offen offset:3072 sc1
    ds_read_b128 v[12:15], v92 offset:57344
    s_waitcnt lgkmcnt(5)
    v_mfma_f32_32x32x16_bf16 v[32:47], v[184:187], v[16:19], v[32:47]
    ds_read_b128 v[16:19], v92 offset:25600
    s_waitcnt lgkmcnt(5)
    v_mfma_f32_32x32x16_bf16 v[48:63], v[184:187], v[20:23], v[48:63]
    s_add_u32 s57, s56, 8192
    buffer_load_dwordx4 v[152:155], v2, s[36:39], s57 offen offset:0 sc1
    ds_read_b128 v[20:23], v92 offset:58368
    s_waitcnt lgkmcnt(5)
    v_mfma_f32_32x32x16_bf16 v[32:47], v[188:191], v[24:27], v[32:47]
    ds_read_b128 v[24:27], v92 offset:26624
    s_waitcnt lgkmcnt(5)
    v_mfma_f32_32x32x16_bf16 v[48:63], v[188:191], v[28:31], v[48:63]
    s_add_u32 s57, s56, 8192
    buffer_load_dwordx4 v[156:159], v2, s[36:39], s57 offen offset:1024 sc1
    ds_read_b128 v[28:31], v92 offset:59392
    s_waitcnt lgkmcnt(5)
    v_mfma_f32_32x32x16_bf16 v[32:47], v[192:195], v[8:11], v[32:47]
    ds_read_b128 v[8:11], v92 offset:27648
    s_waitcnt lgkmcnt(5)
    v_mfma_f32_32x32x16_bf16 v[48:63], v[192:195], v[12:15], v[48:63]
    s_add_u32 s57, s56, 8192
    buffer_load_dwordx4 v[160:163], v2, s[36:39], s57 offen offset:2048 sc1
    ds_read_b128 v[12:15], v92 offset:60416
    s_waitcnt lgkmcnt(5)
    v_mfma_f32_32x32x16_bf16 v[32:47], v[196:199], v[16:19], v[32:47]
    ds_read_b128 v[16:19], v92 offset:28672
    s_waitcnt lgkmcnt(5)
    v_mfma_f32_32x32x16_bf16 v[48:63], v[196:199], v[20:23], v[48:63]
    s_add_u32 s57, s56, 8192
    buffer_load_dwordx4 v[164:167], v2, s[36:39], s57 offen offset:3072 sc1
    v_dot2_f32_bf16 v80, v192, s44, v80
    v_dot2_f32_bf16 v81, v193, s44, v81
    v_dot2_f32_bf16 v82, v194, s44, v82
    v_dot2_f32_bf16 v83, v195, s44, v83
    ds_read_b128 v[20:23], v92 offset:61440
    s_waitcnt lgkmcnt(5)
    v_mfma_f32_32x32x16_bf16 v[32:47], v[200:203], v[24:27], v[32:47]
    ds_read_b128 v[24:27], v92 offset:29696
    s_waitcnt lgkmcnt(5)
    v_mfma_f32_32x32x16_bf16 v[48:63], v[200:203], v[28:31], v[48:63]
    s_add_u32 s57, s56, 12288
    buffer_load_dwordx4 v[168:171], v2, s[36:39], s57 offen offset:0 sc1
    v_dot2_f32_bf16 v80, v196, s44, v80
    v_dot2_f32_bf16 v81, v197, s44, v81
    v_dot2_f32_bf16 v82, v198, s44, v82
    v_dot2_f32_bf16 v83, v199, s44, v83
    ds_read_b128 v[28:31], v92 offset:62464
    s_waitcnt lgkmcnt(5)
    v_mfma_f32_32x32x16_bf16 v[32:47], v[204:207], v[8:11], v[32:47]
    ds_read_b128 v[8:11], v92 offset:30720
    s_waitcnt lgkmcnt(5)
    v_mfma_f32_32x32x16_bf16 v[48:63], v[204:207], v[12:15], v[48:63]
    s_add_u32 s57, s56, 12288
    buffer_load_dwordx4 v[172:175], v2, s[36:39], s57 offen offset:1024 sc1
    v_dot2_f32_bf16 v80, v200, s44, v80
    v_dot2_f32_bf16 v81, v201, s44, v81
    v_dot2_f32_bf16 v82, v202, s44, v82
    v_dot2_f32_bf16 v83, v203, s44, v83
    ds_read_b128 v[12:15], v92 offset:63488
    s_waitcnt lgkmcnt(5)
    v_mfma_f32_32x32x16_bf16 v[32:47], v[208:211], v[16:19], v[32:47]
    ds_read_b128 v[16:19], v92 offset:31744
    s_waitcnt lgkmcnt(5)
    v_mfma_f32_32x32x16_bf16 v[48:63], v[208:211], v[20:23], v[48:63]
    v_dot2_f32_bf16 v80, v204, s44, v80
    v_dot2_f32_bf16 v81, v205, s44, v81
    v_dot2_f32_bf16 v82, v206, s44, v82
    v_dot2_f32_bf16 v83, v207, s44, v83
    ds_read_b128 v[20:23], v92 offset:64512
    s_waitcnt lgkmcnt(5)
    v_mfma_f32_32x32x16_bf16 v[32:47], v[212:215], v[24:27], v[32:47]
    s_waitcnt lgkmcnt(4)
    v_mfma_f32_32x32x16_bf16 v[48:63], v[212:215], v[28:31], v[48:63]
    v_dot2_f32_bf16 v80, v208, s44, v80
    v_dot2_f32_bf16 v81, v209, s44, v81
    v_dot2_f32_bf16 v82, v210, s44, v82
    v_dot2_f32_bf16 v83, v211, s44, v83
    s_waitcnt lgkmcnt(3)
    v_mfma_f32_32x32x16_bf16 v[32:47], v[216:219], v[8:11], v[32:47]
    s_waitcnt lgkmcnt(2)
    v_mfma_f32_32x32x16_bf16 v[48:63], v[216:219], v[12:15], v[48:63]
    v_dot2_f32_bf16 v80, v212, s44, v80
    v_dot2_f32_bf16 v81, v213, s44, v81
    v_dot2_f32_bf16 v82, v214, s44, v82
    v_dot2_f32_bf16 v83, v215, s44, v83
    s_waitcnt lgkmcnt(1)
    v_mfma_f32_32x32x16_bf16 v[32:47], v[220:223], v[16:19], v[32:47]
    s_waitcnt lgkmcnt(0)
    v_mfma_f32_32x32x16_bf16 v[48:63], v[220:223], v[20:23], v[48:63]
    v_dot2_f32_bf16 v80, v216, s44, v80
    v_dot2_f32_bf16 v81, v217, s44, v81
    v_dot2_f32_bf16 v82, v218, s44, v82
    v_dot2_f32_bf16 v83, v219, s44, v83
    v_dot2_f32_bf16 v80, v220, s44, v80
    v_dot2_f32_bf16 v81, v221, s44, v81
    v_dot2_f32_bf16 v82, v222, s44, v82
    v_dot2_f32_bf16 v83, v223, s44, v83
    s_nop 0
    v_add_f32 v80, v80, v81
    s_nop 0
    v_add_f32 v82, v82, v83
    v_add_f32 v80, v80, v82
    v_mov_b32 v81, v80
    s_nop 1
    v_permlane32_swap_b32 v80, v81
    v_add_f32 v80, v80, v81
    s_lshl_b32 s3, s42, 7
    s_add_u32 s3, s3, 160256
    v_and_b32 v93, 31, v1
    v_lshlrev_b32 v93, 2, v93
    v_add_u32 v93, s3, v93
    ds_write_b32 v93, v80
    v_lshrrev_b32 v93, 5, v1
    v_lshlrev_b32 v93, 4, v93
    v_add_u32 v93, s3, v93
    s_waitcnt lgkmcnt(0)
    ds_read_b128 v[72:75], v93 offset:0
    ds_read_b128 v[76:79], v93 offset:32
    ds_read_b128 v[80:83], v93 offset:64
    ds_read_b128 v[84:87], v93 offset:96
    s_branch L_g1_epi
L_g1_stats:
    s_nop 3
    s_waitcnt vmcnt(0)
    s_barrier
    buffer_load_dwordx4 v[224:227], v2, s[36:39], s55 offen offset:0 sc1
    buffer_load_dwordx4 v[228:231], v2, s[36:39], s55 offen offset:1024 sc1
    buffer_load_dwordx4 v[232:235], v2, s[36:39], s55 offen offset:2048 sc1
    buffer_load_dwordx4 v[236:239], v2, s[36:39], s55 offen offset:3072 sc1
    s_add_u32 s57, s55, 4096
    buffer_load_dwordx4 v[240:243], v2, s[36:39], s57 offen offset:0 sc1
    s_add_u32 s57, s55, 4096
    buffer_load_dwordx4 v[244:247], v2, s[36:39], s57 offen offset:1024 sc1
    s_add_u32 s57, s55, 4096
    buffer_load_dwordx4 v[248:251], v2, s[36:39], s57 offen offset:2048 sc1
    s_add_u32 s57, s55, 4096
    buffer_load_dwordx4 v[252:255], v2, s[36:39], s57 offen offset:3072 sc1
    v_add_u32 v92, 65536, v2
    ds_read_b128 v[8:11], v92 offset:0
    ds_read_b128 v[12:15], v92 offset:1024
    ds_read_b128 v[16:19], v92 offset:2048
    ds_read_b128 v[20:23], v92 offset:3072
    s_waitcnt lgkmcnt(3)
    v_dot2_f32_bf16 v64, v8, s44, 0
    v_dot2_f32_bf16 v68, v8, v8, 0
    v_dot2_f32_bf16 v65, v9, s44, 0
    v_dot2_f32_bf16 v69, v9, v9, 0
    v_dot2_f32_bf16 v66, v10, s44, 0
    v_dot2_f32_bf16 v70, v10, v10, 0
    v_dot2_f32_bf16 v67, v11, s44, 0
    v_dot2_f32_bf16 v71, v11, v11, 0
    s_waitcnt lgkmcnt(2)
    v_dot2_f32_bf16 v64, v12, s44, v64
    v_dot2_f32_bf16 v68, v12, v12, v68
    v_dot2_f32_bf16 v65, v13, s44, v65
    v_dot2_f32_bf16 v69, v13, v13, v69
    v_dot2_f32_bf16 v66, v14, s44, v66
    v_dot2_f32_bf16 v70, v14, v14, v70
    v_dot2_f32_bf16 v67, v15, s44, v67
    v_dot2_f32_bf16 v71, v15, v15, v71
    s_waitcnt lgkmcnt(1)
    v_dot2_f32_bf16 v64, v16, s44, v64
    v_dot2_f32_bf16 v68, v16, v16, v68
    v_dot2_f32_bf16 v65, v17, s44, v65
    v_dot2_f32_bf16 v69, v17, v17, v69
    v_dot2_f32_bf16 v66, v18, s44, v66
    v_dot2_f32_bf16 v70, v18, v18, v70
    v_dot2_f32_bf16 v67, v19, s44, v67
    v_dot2_f32_bf16 v71, v19, v19, v71
    s_waitcnt lgkmcnt(0)
    v_dot2_f32_bf16 v64, v20, s44, v64
    v_dot2_f32_bf16 v68, v20, v20, v68
    v_dot2_f32_bf16 v65, v21, s44, v65
    v_dot2_f32_bf16 v69, v21, v21, v69
    v_dot2_f32_bf16 v66, v22, s44, v66
    v_dot2_f32_bf16 v70, v22, v22, v70
    v_dot2_f32_bf16 v67, v23, s44, v67
    v_dot2_f32_bf16 v71, v23, v23, v71
    ds_read_b128 v[8:11], v92 offset:4096
    ds_read_b128 v[12:15], v92 offset:5120
    ds_read_b128 v[16:19], v92 offset:6144
    ds_read_b128 v[20:23], v92 offset:7168
    s_waitcnt lgkmcnt(3)
    v_dot2_f32_bf16 v64, v8, s44, v64
    v_dot2_f32_bf16 v68, v8, v8, v68
    v_dot2_f32_bf16 v65, v9, s44, v65
    v_dot2_f32_bf16 v69, v9, v9, v69
    v_dot2_f32_bf16 v66, v10, s44, v66
    v_dot2_f32_bf16 v70, v10, v10, v70
    v_dot2_f32_bf16 v67, v11, s44, v67
    v_dot2_f32_bf16 v71, v11, v11, v71
    s_waitcnt lgkmcnt(2)
    v_dot2_f32_bf16 v64, v12, s44, v64
    v_dot2_f32_bf16 v68, v12, v12, v68
    v_dot2_f32_bf16 v65, v13, s44, v65
    v_dot2_f32_bf16 v69, v13, v13, v69
    v_dot2_f32_bf16 v66, v14, s44, v66
    v_dot2_f32_bf16 v70, v14, v14, v70
    v_dot2_f32_bf16 v67, v15, s44, v67
    v_dot2_f32_bf16 v71, v15, v15, v71
    s_waitcnt lgkmcnt(1)
    v_dot2_f32_bf16 v64, v16, s44, v64
    v_dot2_f32_bf16 v68, v16, v16, v68
    v_dot2_f32_bf16 v65, v17, s44, v65
    v_dot2_f32_bf16 v69, v17, v17, v69
    v_dot2_f32_bf16 v66, v18, s44, v66
    v_dot2_f32_bf16 v70, v18, v18, v70
    v_dot2_f32_bf16 v67, v19, s44, v67
    v_dot2_f32_bf16 v71, v19, v19, v71
    s_waitcnt lgkmcnt(0)
    v_dot2_f32_bf16 v64, v20, s44, v64
    v_dot2_f32_bf16 v68, v20, v20, v68
    v_dot2_f32_bf16 v65, v21, s44, v65
    v_dot2_f32_bf16 v69, v21, v21, v69
    v_dot2_f32_bf16 v66, v22, s44, v66
    v_dot2_f32_bf16 v70, v22, v22, v70
    v_dot2_f32_bf16 v67, v23, s44, v67
    v_dot2_f32_bf16 v71, v23, v23, v71
    ds_read_b128 v[8:11], v92 offset:8192
    ds_read_b128 v[12:15], v92 offset:9216
    ds_read_b128 v[16:19], v92 offset:10240
    ds_read_b128 v[20:23], v92 offset:11264
    s_waitcnt lgkmcnt(3)
    v_dot2_f32_bf16 v64, v8, s44, v64
    v_dot2_f32_bf16 v68, v8, v8, v68
    v_dot2_f32_bf16 v65, v9, s44, v65
    v_dot2_f32_bf16 v69, v9, v9, v69
    v_dot2_f32_bf16 v66, v10, s44, v66
    v_dot2_f32_bf16 v70, v10, v10, v70
    v_dot2_f32_bf16 v67, v11, s44, v67
    v_dot2_f32_bf16 v71, v11, v11, v71
    s_waitcnt lgkmcnt(2)
    v_dot2_f32_bf16 v64, v12, s44, v64
    v_dot2_f32_bf16 v68, v12, v12, v68
    v_dot2_f32_bf16 v65, v13, s44, v65
    v_dot2_f32_bf16 v69, v13, v13, v69
    v_dot2_f32_bf16 v66, v14, s44, v66
    v_dot2_f32_bf16 v70, v14, v14, v70
    v_dot2_f32_bf16 v67, v15, s44, v67
    v_dot2_f32_bf16 v71, v15, v15, v71
    s_waitcnt lgkmcnt(1)
    v_dot2_f32_bf16 v64, v16, s44, v64
    v_dot2_f32_bf16 v68, v16, v16, v68
    v_dot2_f32_bf16 v65, v17, s44, v65
    v_dot2_f32_bf16 v69, v17, v17, v69
    v_dot2_f32_bf16 v66, v18, s44, v66
    v_dot2_f32_bf16 v70, v18, v18, v70
    v_dot2_f32_bf16 v67, v19, s44, v67
    v_dot2_f32_bf16 v71, v19, v19, v71
    s_waitcnt lgkmcnt(0)
    v_dot2_f32_bf16 v64, v20, s44, v64
    v_dot2_f32_bf16 v68, v20, v20, v68
    v_dot2_f32_bf16 v65, v21, s44, v65
    v_dot2_f32_bf16 v69, v21, v21, v69
    v_dot2_f32_bf16 v66, v22, s44, v66
    v_dot2_f32_bf16 v70, v22, v22, v70
    v_dot2_f32_bf16 v67, v23, s44, v67
    v_dot2_f32_bf16 v71, v23, v23, v71
    ds_read_b128 v[8:11], v92 offset:12288
    ds_read_b128 v[12:15], v92 offset:13312
    ds_read_b128 v[16:19], v92 offset:14336
    ds_read_b128 v[20:23], v92 offset:15360
    s_waitcnt lgkmcnt(3)
    v_dot2_f32_bf16 v64, v8, s44, v64
    v_dot2_f32_bf16 v68, v8, v8, v68
    v_dot2_f32_bf16 v65, v9, s44, v65
    v_dot2_f32_bf16 v69, v9, v9, v69
    v_dot2_f32_bf16 v66, v10, s44, v66
    v_dot2_f32_bf16 v70, v10, v10, v70
    v_dot2_f32_bf16 v67, v11, s44, v67
    v_dot2_f32_bf16 v71, v11, v11, v71
    s_waitcnt lgkmcnt(2)
    v_dot2_f32_bf16 v64, v12, s44, v64
    v_dot2_f32_bf16 v68, v12, v12, v68
    v_dot2_f32_bf16 v65, v13, s44, v65
    v_dot2_f32_bf16 v69, v13, v13, v69
    v_dot2_f32_bf16 v66, v14, s44, v66
    v_dot2_f32_bf16 v70, v14, v14, v70
    v_dot2_f32_bf16 v67, v15, s44, v67
    v_dot2_f32_bf16 v71, v15, v15, v71
    s_waitcnt lgkmcnt(1)
    v_dot2_f32_bf16 v64, v16, s44, v64
    v_dot2_f32_bf16 v68, v16, v16, v68
    v_dot2_f32_bf16 v65, v17, s44, v65
    v_dot2_f32_bf16 v69, v17, v17, v69
    v_dot2_f32_bf16 v66, v18, s44, v66
    v_dot2_f32_bf16 v70, v18, v18, v70
    v_dot2_f32_bf16 v67, v19, s44, v67
    v_dot2_f32_bf16 v71, v19, v19, v71
    s_waitcnt lgkmcnt(0)
    v_dot2_f32_bf16 v64, v20, s44, v64
    v_dot2_f32_bf16 v68, v20, v20, v68
    v_dot2_f32_bf16 v65, v21, s44, v65
    v_dot2_f32_bf16 v69, v21, v21, v69
    v_dot2_f32_bf16 v66, v22, s44, v66
    v_dot2_f32_bf16 v70, v22, v22, v70
    v_dot2_f32_bf16 v67, v23, s44, v67
    v_dot2_f32_bf16 v71, v23, v23, v71
    ds_read_b128 v[8:11], v92 offset:16384
    ds_read_b128 v[12:15], v92 offset:17408
    ds_read_b128 v[16:19], v92 offset:18432
    ds_read_b128 v[20:23], v92 offset:19456
    s_waitcnt lgkmcnt(3)
    v_dot2_f32_bf16 v64, v8, s44, v64
    v_dot2_f32_bf16 v68, v8, v8, v68
    v_dot2_f32_bf16 v65, v9, s44, v65
    v_dot2_f32_bf16 v69, v9, v9, v69
    v_dot2_f32_bf16 v66, v10, s44, v66
    v_dot2_f32_bf16 v70, v10, v10, v70
    v_dot2_f32_bf16 v67, v11, s44, v67
    v_dot2_f32_bf16 v71, v11, v11, v71
    s_waitcnt lgkmcnt(2)
    v_dot2_f32_bf16 v64, v12, s44, v64
    v_dot2_f32_bf16 v68, v12, v12, v68
    v_dot2_f32_bf16 v65, v13, s44, v65
    v_dot2_f32_bf16 v69, v13, v13, v69
    v_dot2_f32_bf16 v66, v14, s44, v66
    v_dot2_f32_bf16 v70, v14, v14, v70
    v_dot2_f32_bf16 v67, v15, s44, v67
    v_dot2_f32_bf16 v71, v15, v15, v71
    s_waitcnt lgkmcnt(1)
    v_dot2_f32_bf16 v64, v16, s44, v64
    v_dot2_f32_bf16 v68, v16, v16, v68
    v_dot2_f32_bf16 v65, v17, s44, v65
    v_dot2_f32_bf16 v69, v17, v17, v69
    v_dot2_f32_bf16 v66, v18, s44, v66
    v_dot2_f32_bf16 v70, v18, v18, v70
    v_dot2_f32_bf16 v67, v19, s44, v67
    v_dot2_f32_bf16 v71, v19, v19, v71
    s_waitcnt lgkmcnt(0)
    v_dot2_f32_bf16 v64, v20, s44, v64
    v_dot2_f32_bf16 v68, v20, v20, v68
    v_dot2_f32_bf16 v65, v21, s44, v65
    v_dot2_f32_bf16 v69, v21, v21, v69
    v_dot2_f32_bf16 v66, v22, s44, v66
    v_dot2_f32_bf16 v70, v22, v22, v70
    v_dot2_f32_bf16 v67, v23, s44, v67
    v_dot2_f32_bf16 v71, v23, v23, v71
    ds_read_b128 v[8:11], v92 offset:20480
    ds_read_b128 v[12:15], v92 offset:21504
    ds_read_b128 v[16:19], v92 offset:22528
    ds_read_b128 v[20:23], v92 offset:23552
    s_waitcnt lgkmcnt(3)
    v_dot2_f32_bf16 v64, v8, s44, v64
    v_dot2_f32_bf16 v68, v8, v8, v68
    v_dot2_f32_bf16 v65, v9, s44, v65
    v_dot2_f32_bf16 v69, v9, v9, v69
    v_dot2_f32_bf16 v66, v10, s44, v66
    v_dot2_f32_bf16 v70, v10, v10, v70
    v_dot2_f32_bf16 v67, v11, s44, v67
    v_dot2_f32_bf16 v71, v11, v11, v71
    s_waitcnt lgkmcnt(2)
    v_dot2_f32_bf16 v64, v12, s44, v64
    v_dot2_f32_bf16 v68, v12, v12, v68
    v_dot2_f32_bf16 v65, v13, s44, v65
    v_dot2_f32_bf16 v69, v13, v13, v69
    v_dot2_f32_bf16 v66, v14, s44, v66
    v_dot2_f32_bf16 v70, v14, v14, v70
    v_dot2_f32_bf16 v67, v15, s44, v67
    v_dot2_f32_bf16 v71, v15, v15, v71
    s_waitcnt lgkmcnt(1)
    v_dot2_f32_bf16 v64, v16, s44, v64
    v_dot2_f32_bf16 v68, v16, v16, v68
    v_dot2_f32_bf16 v65, v17, s44, v65
    v_dot2_f32_bf16 v69, v17, v17, v69
    v_dot2_f32_bf16 v66, v18, s44, v66
    v_dot2_f32_bf16 v70, v18, v18, v70
    v_dot2_f32_bf16 v67, v19, s44, v67
    v_dot2_f32_bf16 v71, v19, v19, v71
    s_waitcnt lgkmcnt(0)
    v_dot2_f32_bf16 v64, v20, s44, v64
    v_dot2_f32_bf16 v68, v20, v20, v68
    v_dot2_f32_bf16 v65, v21, s44, v65
    v_dot2_f32_bf16 v69, v21, v21, v69
    v_dot2_f32_bf16 v66, v22, s44, v66
    v_dot2_f32_bf16 v70, v22, v22, v70
    v_dot2_f32_bf16 v67, v23, s44, v67
    v_dot2_f32_bf16 v71, v23, v23, v71
    ds_read_b128 v[8:11], v92 offset:24576
    ds_read_b128 v[12:15], v92 offset:25600
    ds_read_b128 v[16:19], v92 offset:26624
    ds_read_b128 v[20:23], v92 offset:27648
    s_waitcnt lgkmcnt(3)
    v_dot2_f32_bf16 v64, v8, s44, v64
    v_dot2_f32_bf16 v68, v8, v8, v68
    v_dot2_f32_bf16 v65, v9, s44, v65
    v_dot2_f32_bf16 v69, v9, v9, v69
    v_dot2_f32_bf16 v66, v10, s44, v66
    v_dot2_f32_bf16 v70, v10, v10, v70
    v_dot2_f32_bf16 v67, v11, s44, v67
    v_dot2_f32_bf16 v71, v11, v11, v71
    s_waitcnt lgkmcnt(2)
    v_dot2_f32_bf16 v64, v12, s44, v64
    v_dot2_f32_bf16 v68, v12, v12, v68
    v_dot2_f32_bf16 v65, v13, s44, v65
    v_dot2_f32_bf16 v69, v13, v13, v69
    v_dot2_f32_bf16 v66, v14, s44, v66
    v_dot2_f32_bf16 v70, v14, v14, v70
    v_dot2_f32_bf16 v67, v15, s44, v67
    v_dot2_f32_bf16 v71, v15, v15, v71
    s_waitcnt lgkmcnt(1)
    v_dot2_f32_bf16 v64, v16, s44, v64
    v_dot2_f32_bf16 v68, v16, v16, v68
    v_dot2_f32_bf16 v65, v17, s44, v65
    v_dot2_f32_bf16 v69, v17, v17, v69
    v_dot2_f32_bf16 v66, v18, s44, v66
    v_dot2_f32_bf16 v70, v18, v18, v70
    v_dot2_f32_bf16 v67, v19, s44, v67
    v_dot2_f32_bf16 v71, v19, v19, v71
    s_waitcnt lgkmcnt(0)
    v_dot2_f32_bf16 v64, v20, s44, v64
    v_dot2_f32_bf16 v68, v20, v20, v68
    v_dot2_f32_bf16 v65, v21, s44, v65
    v_dot2_f32_bf16 v69, v21, v21, v69
    v_dot2_f32_bf16 v66, v22, s44, v66
    v_dot2_f32_bf16 v70, v22, v22, v70
    v_dot2_f32_bf16 v67, v23, s44, v67
    v_dot2_f32_bf16 v71, v23, v23, v71
    ds_read_b128 v[8:11], v92 offset:28672
    ds_read_b128 v[12:15], v92 offset:29696
    ds_read_b128 v[16:19], v92 offset:30720
    ds_read_b128 v[20:23], v92 offset:31744
    s_waitcnt lgkmcnt(3)
    v_dot2_f32_bf16 v64, v8, s44, v64
    v_dot2_f32_bf16 v68, v8, v8, v68
    v_dot2_f32_bf16 v65, v9, s44, v65
    v_dot2_f32_bf16 v69, v9, v9, v69
    v_dot2_f32_bf16 v66, v10, s44, v66
    v_dot2_f32_bf16 v70, v10, v10, v70
    v_dot2_f32_bf16 v67, v11, s44, v67
    v_dot2_f32_bf16 v71, v11, v11, v71
    s_waitcnt lgkmcnt(2)
    v_dot2_f32_bf16 v64, v12, s44, v64
    v_dot2_f32_bf16 v68, v12, v12, v68
    v_dot2_f32_bf16 v65, v13, s44, v65
    v_dot2_f32_bf16 v69, v13, v13, v69
    v_dot2_f32_bf16 v66, v14, s44, v66
    v_dot2_f32_bf16 v70, v14, v14, v70
    v_dot2_f32_bf16 v67, v15, s44, v67
    v_dot2_f32_bf16 v71, v15, v15, v71
    s_waitcnt lgkmcnt(1)
    v_dot2_f32_bf16 v64, v16, s44, v64
    v_dot2_f32_bf16 v68, v16, v16, v68
    v_dot2_f32_bf16 v65, v17, s44, v65
    v_dot2_f32_bf16 v69, v17, v17, v69
    v_dot2_f32_bf16 v66, v18, s44, v66
    v_dot2_f32_bf16 v70, v18, v18, v70
    v_dot2_f32_bf16 v67, v19, s44, v67
    v_dot2_f32_bf16 v71, v19, v19, v71
    s_waitcnt lgkmcnt(0)
    v_dot2_f32_bf16 v64, v20, s44, v64
    v_dot2_f32_bf16 v68, v20, v20, v68
    v_dot2_f32_bf16 v65, v21, s44, v65
    v_dot2_f32_bf16 v69, v21, v21, v69
    v_dot2_f32_bf16 v66, v22, s44, v66
    v_dot2_f32_bf16 v70, v22, v22, v70
    v_dot2_f32_bf16 v67, v23, s44, v67
    v_dot2_f32_bf16 v71, v23, v23, v71
    v_add_f32 v64, v64, v65
    s_nop 0
    v_add_f32 v66, v66, v67
    v_add_f32 v64, v64, v66
    v_add_f32 v68, v68, v69
    v_add_f32 v70, v70, v71
    v_add_f32 v68, v68, v70
    ds_read_b128 v[8:11], v92 offset:32768
    ds_read_b128 v[12:15], v92 offset:33792
    ds_read_b128 v[16:19], v92 offset:34816
    ds_read_b128 v[20:23], v92 offset:35840
    s_waitcnt lgkmcnt(3)
    v_dot2_f32_bf16 v72, v8, s44, 0
    v_dot2_f32_bf16 v76, v8, v8, 0
    v_dot2_f32_bf16 v73, v9, s44, 0
    v_dot2_f32_bf16 v77, v9, v9, 0
    v_dot2_f32_bf16 v74, v10, s44, 0
    v_dot2_f32_bf16 v78, v10, v10, 0
    v_dot2_f32_bf16 v75, v11, s44, 0
    v_dot2_f32_bf16 v79, v11, v11, 0
    s_waitcnt lgkmcnt(2)
    v_dot2_f32_bf16 v72, v12, s44, v72
    v_dot2_f32_bf16 v76, v12, v12, v76
    v_dot2_f32_bf16 v73, v13, s44, v73
    v_dot2_f32_bf16 v77, v13, v13, v77
    v_dot2_f32_bf16 v74, v14, s44, v74
    v_dot2_f32_bf16 v78, v14, v14, v78
    v_dot2_f32_bf16 v75, v15, s44, v75
    v_dot2_f32_bf16 v79, v15, v15, v79
    s_waitcnt lgkmcnt(1)
    v_dot2_f32_bf16 v72, v16, s44, v72
    v_dot2_f32_bf16 v76, v16, v16, v76
    v_dot2_f32_bf16 v73, v17, s44, v73
    v_dot2_f32_bf16 v77, v17, v17, v77
    v_dot2_f32_bf16 v74, v18, s44, v74
    v_dot2_f32_bf16 v78, v18, v18, v78
    v_dot2_f32_bf16 v75, v19, s44, v75
    v_dot2_f32_bf16 v79, v19, v19, v79
    s_waitcnt lgkmcnt(0)
    v_dot2_f32_bf16 v72, v20, s44, v72
    v_dot2_f32_bf16 v76, v20, v20, v76
    v_dot2_f32_bf16 v73, v21, s44, v73
    v_dot2_f32_bf16 v77, v21, v21, v77
    v_dot2_f32_bf16 v74, v22, s44, v74
    v_dot2_f32_bf16 v78, v22, v22, v78
    v_dot2_f32_bf16 v75, v23, s44, v75
    v_dot2_f32_bf16 v79, v23, v23, v79
    ds_read_b128 v[8:11], v92 offset:36864
    ds_read_b128 v[12:15], v92 offset:37888
    ds_read_b128 v[16:19], v92 offset:38912
    ds_read_b128 v[20:23], v92 offset:39936
    s_waitcnt lgkmcnt(3)
    v_dot2_f32_bf16 v72, v8, s44, v72
    v_dot2_f32_bf16 v76, v8, v8, v76
    v_dot2_f32_bf16 v73, v9, s44, v73
    v_dot2_f32_bf16 v77, v9, v9, v77
    v_dot2_f32_bf16 v74, v10, s44, v74
    v_dot2_f32_bf16 v78, v10, v10, v78
    v_dot2_f32_bf16 v75, v11, s44, v75
    v_dot2_f32_bf16 v79, v11, v11, v79
    s_waitcnt lgkmcnt(2)
    v_dot2_f32_bf16 v72, v12, s44, v72
    v_dot2_f32_bf16 v76, v12, v12, v76
    v_dot2_f32_bf16 v73, v13, s44, v73
    v_dot2_f32_bf16 v77, v13, v13, v77
    v_dot2_f32_bf16 v74, v14, s44, v74
    v_dot2_f32_bf16 v78, v14, v14, v78
    v_dot2_f32_bf16 v75, v15, s44, v75
    v_dot2_f32_bf16 v79, v15, v15, v79
    s_waitcnt lgkmcnt(1)
    v_dot2_f32_bf16 v72, v16, s44, v72
    v_dot2_f32_bf16 v76, v16, v16, v76
    v_dot2_f32_bf16 v73, v17, s44, v73
    v_dot2_f32_bf16 v77, v17, v17, v77
    v_dot2_f32_bf16 v74, v18, s44, v74
    v_dot2_f32_bf16 v78, v18, v18, v78
    v_dot2_f32_bf16 v75, v19, s44, v75
    v_dot2_f32_bf16 v79, v19, v19, v79
    s_waitcnt lgkmcnt(0)
    v_dot2_f32_bf16 v72, v20, s44, v72
    v_dot2_f32_bf16 v76, v20, v20, v76
    v_dot2_f32_bf16 v73, v21, s44, v73
    v_dot2_f32_bf16 v77, v21, v21, v77
    v_dot2_f32_bf16 v74, v22, s44, v74
    v_dot2_f32_bf16 v78, v22, v22, v78
    v_dot2_f32_bf16 v75, v23, s44, v75
    v_dot2_f32_bf16 v79, v23, v23, v79
    ds_read_b128 v[8:11], v92 offset:40960
    ds_read_b128 v[12:15], v92 offset:41984
    ds_read_b128 v[16:19], v92 offset:43008
    ds_read_b128 v[20:23], v92 offset:44032
    s_waitcnt lgkmcnt(3)
    v_dot2_f32_bf16 v72, v8, s44, v72
    v_dot2_f32_bf16 v76, v8, v8, v76
    v_dot2_f32_bf16 v73, v9, s44, v73
    v_dot2_f32_bf16 v77, v9, v9, v77
    v_dot2_f32_bf16 v74, v10, s44, v74
    v_dot2_f32_bf16 v78, v10, v10, v78
    v_dot2_f32_bf16 v75, v11, s44, v75
    v_dot2_f32_bf16 v79, v11, v11, v79
    s_waitcnt lgkmcnt(2)
    v_dot2_f32_bf16 v72, v12, s44, v72
    v_dot2_f32_bf16 v76, v12, v12, v76
    v_dot2_f32_bf16 v73, v13, s44, v73
    v_dot2_f32_bf16 v77, v13, v13, v77
    v_dot2_f32_bf16 v74, v14, s44, v74
    v_dot2_f32_bf16 v78, v14, v14, v78
    v_dot2_f32_bf16 v75, v15, s44, v75
    v_dot2_f32_bf16 v79, v15, v15, v79
    s_waitcnt lgkmcnt(1)
    v_dot2_f32_bf16 v72, v16, s44, v72
    v_dot2_f32_bf16 v76, v16, v16, v76
    v_dot2_f32_bf16 v73, v17, s44, v73
    v_dot2_f32_bf16 v77, v17, v17, v77
    v_dot2_f32_bf16 v74, v18, s44, v74
    v_dot2_f32_bf16 v78, v18, v18, v78
    v_dot2_f32_bf16 v75, v19, s44, v75
    v_dot2_f32_bf16 v79, v19, v19, v79
    s_waitcnt lgkmcnt(0)
    v_dot2_f32_bf16 v72, v20, s44, v72
    v_dot2_f32_bf16 v76, v20, v20, v76
    v_dot2_f32_bf16 v73, v21, s44, v73
    v_dot2_f32_bf16 v77, v21, v21, v77
    v_dot2_f32_bf16 v74, v22, s44, v74
    v_dot2_f32_bf16 v78, v22, v22, v78
    v_dot2_f32_bf16 v75, v23, s44, v75
    v_dot2_f32_bf16 v79, v23, v23, v79
    ds_read_b128 v[8:11], v92 offset:45056
    ds_read_b128 v[12:15], v92 offset:46080
    ds_read_b128 v[16:19], v92 offset:47104
    ds_read_b128 v[20:23], v92 offset:48128
    s_waitcnt lgkmcnt(3)
    v_dot2_f32_bf16 v72, v8, s44, v72
    v_dot2_f32_bf16 v76, v8, v8, v76
    v_dot2_f32_bf16 v73, v9, s44, v73
    v_dot2_f32_bf16 v77, v9, v9, v77
    v_dot2_f32_bf16 v74, v10, s44, v74
    v_dot2_f32_bf16 v78, v10, v10, v78
    v_dot2_f32_bf16 v75, v11, s44, v75
    v_dot2_f32_bf16 v79, v11, v11, v79
    s_waitcnt lgkmcnt(2)
    v_dot2_f32_bf16 v72, v12, s44, v72
    v_dot2_f32_bf16 v76, v12, v12, v76
    v_dot2_f32_bf16 v73, v13, s44, v73
    v_dot2_f32_bf16 v77, v13, v13, v77
    v_dot2_f32_bf16 v74, v14, s44, v74
    v_dot2_f32_bf16 v78, v14, v14, v78
    v_dot2_f32_bf16 v75, v15, s44, v75
    v_dot2_f32_bf16 v79, v15, v15, v79
    s_waitcnt lgkmcnt(1)
    v_dot2_f32_bf16 v72, v16, s44, v72
    v_dot2_f32_bf16 v76, v16, v16, v76
    v_dot2_f32_bf16 v73, v17, s44, v73
    v_dot2_f32_bf16 v77, v17, v17, v77
    v_dot2_f32_bf16 v74, v18, s44, v74
    v_dot2_f32_bf16 v78, v18, v18, v78
    v_dot2_f32_bf16 v75, v19, s44, v75
    v_dot2_f32_bf16 v79, v19, v19, v79
    s_waitcnt lgkmcnt(0)
    v_dot2_f32_bf16 v72, v20, s44, v72
    v_dot2_f32_bf16 v76, v20, v20, v76
    v_dot2_f32_bf16 v73, v21, s44, v73
    v_dot2_f32_bf16 v77, v21, v21, v77
    v_dot2_f32_bf16 v74, v22, s44, v74
    v_dot2_f32_bf16 v78, v22, v22, v78
    v_dot2_f32_bf16 v75, v23, s44, v75
    v_dot2_f32_bf16 v79, v23, v23, v79
    ds_read_b128 v[8:11], v92 offset:49152
    ds_read_b128 v[12:15], v92 offset:50176
    ds_read_b128 v[16:19], v92 offset:51200
    ds_read_b128 v[20:23], v92 offset:52224
    s_waitcnt lgkmcnt(3)
    v_dot2_f32_bf16 v72, v8, s44, v72
    v_dot2_f32_bf16 v76, v8, v8, v76
    v_dot2_f32_bf16 v73, v9, s44, v73
    v_dot2_f32_bf16 v77, v9, v9, v77
    v_dot2_f32_bf16 v74, v10, s44, v74
    v_dot2_f32_bf16 v78, v10, v10, v78
    v_dot2_f32_bf16 v75, v11, s44, v75
    v_dot2_f32_bf16 v79, v11, v11, v79
    s_waitcnt lgkmcnt(2)
    v_dot2_f32_bf16 v72, v12, s44, v72
    v_dot2_f32_bf16 v76, v12, v12, v76
    v_dot2_f32_bf16 v73, v13, s44, v73
    v_dot2_f32_bf16 v77, v13, v13, v77
    v_dot2_f32_bf16 v74, v14, s44, v74
    v_dot2_f32_bf16 v78, v14, v14, v78
    v_dot2_f32_bf16 v75, v15, s44, v75
    v_dot2_f32_bf16 v79, v15, v15, v79
    s_waitcnt lgkmcnt(1)
    v_dot2_f32_bf16 v72, v16, s44, v72
    v_dot2_f32_bf16 v76, v16, v16, v76
    v_dot2_f32_bf16 v73, v17, s44, v73
    v_dot2_f32_bf16 v77, v17, v17, v77
    v_dot2_f32_bf16 v74, v18, s44, v74
    v_dot2_f32_bf16 v78, v18, v18, v78
    v_dot2_f32_bf16 v75, v19, s44, v75
    v_dot2_f32_bf16 v79, v19, v19, v79
    s_waitcnt lgkmcnt(0)
    v_dot2_f32_bf16 v72, v20, s44, v72
    v_dot2_f32_bf16 v76, v20, v20, v76
    v_dot2_f32_bf16 v73, v21, s44, v73
    v_dot2_f32_bf16 v77, v21, v21, v77
    v_dot2_f32_bf16 v74, v22, s44, v74
    v_dot2_f32_bf16 v78, v22, v22, v78
    v_dot2_f32_bf16 v75, v23, s44, v75
    v_dot2_f32_bf16 v79, v23, v23, v79
    ds_read_b128 v[8:11], v92 offset:53248
    ds_read_b128 v[12:15], v92 offset:54272
    ds_read_b128 v[16:19], v92 offset:55296
    ds_read_b128 v[20:23], v92 offset:56320
    s_waitcnt lgkmcnt(3)
    v_dot2_f32_bf16 v72, v8, s44, v72
    v_dot2_f32_bf16 v76, v8, v8, v76
    v_dot2_f32_bf16 v73, v9, s44, v73
    v_dot2_f32_bf16 v77, v9, v9, v77
    v_dot2_f32_bf16 v74, v10, s44, v74
    v_dot2_f32_bf16 v78, v10, v10, v78
    v_dot2_f32_bf16 v75, v11, s44, v75
    v_dot2_f32_bf16 v79, v11, v11, v79
    s_waitcnt lgkmcnt(2)
    v_dot2_f32_bf16 v72, v12, s44, v72
    v_dot2_f32_bf16 v76, v12, v12, v76
    v_dot2_f32_bf16 v73, v13, s44, v73
    v_dot2_f32_bf16 v77, v13, v13, v77
    v_dot2_f32_bf16 v74, v14, s44, v74
    v_dot2_f32_bf16 v78, v14, v14, v78
    v_dot2_f32_bf16 v75, v15, s44, v75
    v_dot2_f32_bf16 v79, v15, v15, v79
    s_waitcnt lgkmcnt(1)
    v_dot2_f32_bf16 v72, v16, s44, v72
    v_dot2_f32_bf16 v76, v16, v16, v76
    v_dot2_f32_bf16 v73, v17, s44, v73
    v_dot2_f32_bf16 v77, v17, v17, v77
    v_dot2_f32_bf16 v74, v18, s44, v74
    v_dot2_f32_bf16 v78, v18, v18, v78
    v_dot2_f32_bf16 v75, v19, s44, v75
    v_dot2_f32_bf16 v79, v19, v19, v79
    s_waitcnt lgkmcnt(0)
    v_dot2_f32_bf16 v72, v20, s44, v72
    v_dot2_f32_bf16 v76, v20, v20, v76
    v_dot2_f32_bf16 v73, v21, s44, v73
    v_dot2_f32_bf16 v77, v21, v21, v77
    v_dot2_f32_bf16 v74, v22, s44, v74
    v_dot2_f32_bf16 v78, v22, v22, v78
    v_dot2_f32_bf16 v75, v23, s44, v75
    v_dot2_f32_bf16 v79, v23, v23, v79
    ds_read_b128 v[8:11], v92 offset:57344
    ds_read_b128 v[12:15], v92 offset:58368
    ds_read_b128 v[16:19], v92 offset:59392
    ds_read_b128 v[20:23], v92 offset:60416
    s_waitcnt lgkmcnt(3)
    v_dot2_f32_bf16 v72, v8, s44, v72
    v_dot2_f32_bf16 v76, v8, v8, v76
    v_dot2_f32_bf16 v73, v9, s44, v73
    v_dot2_f32_bf16 v77, v9, v9, v77
    v_dot2_f32_bf16 v74, v10, s44, v74
    v_dot2_f32_bf16 v78, v10, v10, v78
    v_dot2_f32_bf16 v75, v11, s44, v75
    v_dot2_f32_bf16 v79, v11, v11, v79
    s_waitcnt lgkmcnt(2)
    v_dot2_f32_bf16 v72, v12, s44, v72
    v_dot2_f32_bf16 v76, v12, v12, v76
    v_dot2_f32_bf16 v73, v13, s44, v73
    v_dot2_f32_bf16 v77, v13, v13, v77
    v_dot2_f32_bf16 v74, v14, s44, v74
    v_dot2_f32_bf16 v78, v14, v14, v78
    v_dot2_f32_bf16 v75, v15, s44, v75
    v_dot2_f32_bf16 v79, v15, v15, v79
    s_waitcnt lgkmcnt(1)
    v_dot2_f32_bf16 v72, v16, s44, v72
    v_dot2_f32_bf16 v76, v16, v16, v76
    v_dot2_f32_bf16 v73, v17, s44, v73
    v_dot2_f32_bf16 v77, v17, v17, v77
    v_dot2_f32_bf16 v74, v18, s44, v74
    v_dot2_f32_bf16 v78, v18, v18, v78
    v_dot2_f32_bf16 v75, v19, s44, v75
    v_dot2_f32_bf16 v79, v19, v19, v79
    s_waitcnt lgkmcnt(0)
    v_dot2_f32_bf16 v72, v20, s44, v72
    v_dot2_f32_bf16 v76, v20, v20, v76
    v_dot2_f32_bf16 v73, v21, s44, v73
    v_dot2_f32_bf16 v77, v21, v21, v77
    v_dot2_f32_bf16 v74, v22, s44, v74
    v_dot2_f32_bf16 v78, v22, v22, v78
    v_dot2_f32_bf16 v75, v23, s44, v75
    v_dot2_f32_bf16 v79, v23, v23, v79
    ds_read_b128 v[8:11], v92 offset:61440
    ds_read_b128 v[12:15], v92 offset:62464
    ds_read_b128 v[16:19], v92 offset:63488
    ds_read_b128 v[20:23], v92 offset:64512
    s_waitcnt lgkmcnt(3)
    v_dot2_f32_bf16 v72, v8, s44, v72
    v_dot2_f32_bf16 v76, v8, v8, v76
    v_dot2_f32_bf16 v73, v9, s44, v73
    v_dot2_f32_bf16 v77, v9, v9, v77
    v_dot2_f32_bf16 v74, v10, s44, v74
    v_dot2_f32_bf16 v78, v10, v10, v78
    v_dot2_f32_bf16 v75, v11, s44, v75
    v_dot2_f32_bf16 v79, v11, v11, v79
    s_waitcnt lgkmcnt(2)
    v_dot2_f32_bf16 v72, v12, s44, v72
    v_dot2_f32_bf16 v76, v12, v12, v76
    v_dot2_f32_bf16 v73, v13, s44, v73
    v_dot2_f32_bf16 v77, v13, v13, v77
    v_dot2_f32_bf16 v74, v14, s44, v74
    v_dot2_f32_bf16 v78, v14, v14, v78
    v_dot2_f32_bf16 v75, v15, s44, v75
    v_dot2_f32_bf16 v79, v15, v15, v79
    s_waitcnt lgkmcnt(1)
    v_dot2_f32_bf16 v72, v16, s44, v72
    v_dot2_f32_bf16 v76, v16, v16, v76
    v_dot2_f32_bf16 v73, v17, s44, v73
    v_dot2_f32_bf16 v77, v17, v17, v77
    v_dot2_f32_bf16 v74, v18, s44, v74
    v_dot2_f32_bf16 v78, v18, v18, v78
    v_dot2_f32_bf16 v75, v19, s44, v75
    v_dot2_f32_bf16 v79, v19, v19, v79
    s_waitcnt lgkmcnt(0)
    v_dot2_f32_bf16 v72, v20, s44, v72
    v_dot2_f32_bf16 v76, v20, v20, v76
    v_dot2_f32_bf16 v73, v21, s44, v73
    v_dot2_f32_bf16 v77, v21, v21, v77
    v_dot2_f32_bf16 v74, v22, s44, v74
    v_dot2_f32_bf16 v78, v22, v22, v78
    v_dot2_f32_bf16 v75, v23, s44, v75
    v_dot2_f32_bf16 v79, v23, v23, v79
    v_add_f32 v72, v72, v73
    s_nop 0
    v_add_f32 v74, v74, v75
    v_add_f32 v72, v72, v74
    v_add_f32 v76, v76, v77
    v_add_f32 v78, v78, v79
    v_add_f32 v76, v76, v78
    v_permlane32_swap_b32 v64, v72
    v_add_f32 v64, v64, v72
    v_permlane32_swap_b32 v68, v76
    v_add_f32 v68, v68, v76
    s_mov_b32 s45, 0x3b000000
    s_mov_b32 s46, 0x3727c5ac
    v_mul_f32 v64, s45, v64
    v_mul_f32 v65, v64, v64
    v_fma_f32 v68, v68, s45, -v65
    v_add_f32 v68, s46, v68
    v_rsq_f32 v68, v68
    s_mov_b32 s45, 0x3fb8aa3b
    v_mul_f32 v68, s45, v68
    v_mul_f32_e64 v69, -v64, v68
    v_lshlrev_b32 v93, 3, v1
    v_add_u32 v93, 159744, v93
    ds_write_b64 v93, v[68:69]
    s_cmp_ge_u32 s2, 8
    s_cbranch_scc1 L_g1_epi
    buffer_wbl2 sc1
L_g1_epi:
    s_nop 11
    s_waitcnt lgkmcnt(0)
    s_barrier
    s_cmp_eq_u32 s42, 7
    s_cbranch_scc1 L_g1_done
    v_and_b32 v88, 31, v1
    v_lshlrev_b32 v88, 3, v88
    v_add_u32 v88, 159744, v88
    ds_read_b64 v[90:91], v88 offset:256
    ds_read_b64 v[88:89], v88
    s_waitcnt vmcnt(28)
    v_lshlrev_b32 v8, 16, v64
    v_and_b32 v9, 0xffff0000, v64
    v_lshlrev_b32 v10, 16, v65
    v_and_b32 v11, 0xffff0000, v65
    v_lshlrev_b32 v12, 16, v66
    v_and_b32 v13, 0xffff0000, v66
    v_lshlrev_b32 v14, 16, v67
    v_and_b32 v15, 0xffff0000, v67
    v_lshlrev_b32 v16, 16, v68
    v_and_b32 v17, 0xffff0000, v68
    v_lshlrev_b32 v18, 16, v69
    v_and_b32 v19, 0xffff0000, v69
    v_lshlrev_b32 v20, 16, v70
    v_and_b32 v21, 0xffff0000, v70
    v_lshlrev_b32 v22, 16, v71
    v_and_b32 v23, 0xffff0000, v71
    s_mov_b32 s58, 0x3fb8aa3b
    s_mov_b32 s59, s58
    v_pk_mul_f32 v[8:9], v[8:9], s[58:59]
    v_pk_mul_f32 v[10:11], v[10:11], s[58:59]
    v_pk_mul_f32 v[12:13], v[12:13], s[58:59]
    v_pk_mul_f32 v[14:15], v[14:15], s[58:59]
    v_pk_mul_f32 v[16:17], v[16:17], s[58:59]
    v_pk_mul_f32 v[18:19], v[18:19], s[58:59]
    v_pk_mul_f32 v[20:21], v[20:21], s[58:59]
    v_pk_mul_f32 v[22:23], v[22:23], s[58:59]
    s_lshl_b32 s3, s41, 3
    s_add_u32 s3, s3, s40
    s_mul_i32 s3, s3, 28
    s_lshl_b32 s43, s42, 1
    s_add_u32 s3, s3, s43
    s_lshl_b32 s3, s3, 10
    s_add_u32 s48, s3, 0xb00000
    s_add_u32 s49, s48, 14336
    s_mov_b32 s60, 0.5
    s_mov_b32 s61, 0.5
    s_waitcnt lgkmcnt(0)
    v_pk_fma_f32 v[24:25], v[72:73], v[88:89], v[8:9] op_sel:[0,1,0] op_sel_hi:[1,1,1]
    v_pk_fma_f32 v[26:27], v[74:75], v[88:89], v[10:11] op_sel:[0,1,0] op_sel_hi:[1,1,1]
    v_pk_fma_f32 v[28:29], v[76:77], v[88:89], v[12:13] op_sel:[0,1,0] op_sel_hi:[1,1,1]
    v_pk_fma_f32 v[30:31], v[78:79], v[88:89], v[14:15] op_sel:[0,1,0] op_sel_hi:[1,1,1]
    v_pk_fma_f32 v[32:33], v[32:33], v[88:89], v[24:25] op_sel:[0,0,0] op_sel_hi:[1,0,1]
    v_pk_fma_f32 v[34:35], v[34:35], v[88:89], v[26:27] op_sel:[0,0,0] op_sel_hi:[1,0,1]
    v_pk_fma_f32 v[36:37], v[36:37], v[88:89], v[28:29] op_sel:[0,0,0] op_sel_hi:[1,0,1]
    v_pk_fma_f32 v[38:39], v[38:39], v[88:89], v[30:31] op_sel:[0,0,0] op_sel_hi:[1,0,1]
    v_exp_f32 v24, v32
    v_exp_f32 v25, v33
    v_exp_f32 v26, v34
    v_exp_f32 v27, v35
    v_exp_f32 v28, v36
    v_exp_f32 v29, v37
    v_exp_f32 v30, v38
    v_exp_f32 v31, v39
    v_pk_fma_f32 v[64:65], v[24:25], s[60:61], 1.0 op_sel_hi:[1,1,0]
    v_pk_fma_f32 v[66:67], v[26:27], s[60:61], 1.0 op_sel_hi:[1,1,0]
    v_pk_fma_f32 v[68:69], v[28:29], s[60:61], 1.0 op_sel_hi:[1,1,0]
    v_pk_fma_f32 v[70:71], v[30:31], s[60:61], 1.0 op_sel_hi:[1,1,0]
    v_pk_fma_f32 v[64:65], v[24:25], v[64:65], 1.0 op_sel_hi:[1,1,0]
    v_pk_fma_f32 v[66:67], v[26:27], v[66:67], 1.0 op_sel_hi:[1,1,0]
    v_pk_fma_f32 v[68:69], v[28:29], v[68:69], 1.0 op_sel_hi:[1,1,0]
    v_pk_fma_f32 v[70:71], v[30:31], v[70:71], 1.0 op_sel_hi:[1,1,0]
    v_rcp_f32 v64, v64
    v_rcp_f32 v65, v65
    v_rcp_f32 v66, v66
    v_rcp_f32 v67, v67
    v_rcp_f32 v68, v68
    v_rcp_f32 v69, v69
    v_rcp_f32 v70, v70
    v_rcp_f32 v71, v71
    v_pk_fma_f32 v[32:33], v[32:33], v[64:65], v[32:33] neg_lo:[1,0,0] neg_hi:[1,0,0]
    v_pk_fma_f32 v[34:35], v[34:35], v[66:67], v[34:35] neg_lo:[1,0,0] neg_hi:[1,0,0]
    v_pk_fma_f32 v[36:37], v[36:37], v[68:69], v[36:37] neg_lo:[1,0,0] neg_hi:[1,0,0]
    v_pk_fma_f32 v[38:39], v[38:39], v[70:71], v[38:39] neg_lo:[1,0,0] neg_hi:[1,0,0]
    v_cvt_pk_bf16_f32 v176, v32, v33
    v_cvt_pk_bf16_f32 v177, v34, v35
    v_cvt_pk_bf16_f32 v178, v36, v37
    v_cvt_pk_bf16_f32 v179, v38, v39
    buffer_store_dwordx4 v[176:179], v2, s[36:39], s48 offen offset:0 sc1
    v_pk_fma_f32 v[24:25], v[80:81], v[88:89], v[16:17] op_sel:[0,1,0] op_sel_hi:[1,1,1]
    v_pk_fma_f32 v[26:27], v[82:83], v[88:89], v[18:19] op_sel:[0,1,0] op_sel_hi:[1,1,1]
    v_pk_fma_f32 v[28:29], v[84:85], v[88:89], v[20:21] op_sel:[0,1,0] op_sel_hi:[1,1,1]
    v_pk_fma_f32 v[30:31], v[86:87], v[88:89], v[22:23] op_sel:[0,1,0] op_sel_hi:[1,1,1]
    v_pk_fma_f32 v[40:41], v[40:41], v[88:89], v[24:25] op_sel:[0,0,0] op_sel_hi:[1,0,1]
    v_pk_fma_f32 v[42:43], v[42:43], v[88:89], v[26:27] op_sel:[0,0,0] op_sel_hi:[1,0,1]
    v_pk_fma_f32 v[44:45], v[44:45], v[88:89], v[28:29] op_sel:[0,0,0] op_sel_hi:[1,0,1]
    v_pk_fma_f32 v[46:47], v[46:47], v[88:89], v[30:31] op_sel:[0,0,0] op_sel_hi:[1,0,1]
    v_exp_f32 v24, v40
    v_exp_f32 v25, v41
    v_exp_f32 v26, v42
    v_exp_f32 v27, v43
    v_exp_f32 v28, v44
    v_exp_f32 v29, v45
    v_exp_f32 v30, v46
    v_exp_f32 v31, v47
    v_pk_fma_f32 v[64:65], v[24:25], s[60:61], 1.0 op_sel_hi:[1,1,0]
    v_pk_fma_f32 v[66:67], v[26:27], s[60:61], 1.0 op_sel_hi:[1,1,0]
    v_pk_fma_f32 v[68:69], v[28:29], s[60:61], 1.0 op_sel_hi:[1,1,0]
    v_pk_fma_f32 v[70:71], v[30:31], s[60:61], 1.0 op_sel_hi:[1,1,0]
    v_pk_fma_f32 v[64:65], v[24:25], v[64:65], 1.0 op_sel_hi:[1,1,0]
    v_pk_fma_f32 v[66:67], v[26:27], v[66:67], 1.0 op_sel_hi:[1,1,0]
    v_pk_fma_f32 v[68:69], v[28:29], v[68:69], 1.0 op_sel_hi:[1,1,0]
    v_pk_fma_f32 v[70:71], v[30:31], v[70:71], 1.0 op_sel_hi:[1,1,0]
    v_rcp_f32 v64, v64
    v_rcp_f32 v65, v65
    v_rcp_f32 v66, v66
    v_rcp_f32 v67, v67
    v_rcp_f32 v68, v68
    v_rcp_f32 v69, v69
    v_rcp_f32 v70, v70
    v_rcp_f32 v71, v71
    v_pk_fma_f32 v[40:41], v[40:41], v[64:65], v[40:41] neg_lo:[1,0,0] neg_hi:[1,0,0]
    v_pk_fma_f32 v[42:43], v[42:43], v[66:67], v[42:43] neg_lo:[1,0,0] neg_hi:[1,0,0]
    v_pk_fma_f32 v[44:45], v[44:45], v[68:69], v[44:45] neg_lo:[1,0,0] neg_hi:[1,0,0]
    v_pk_fma_f32 v[46:47], v[46:47], v[70:71], v[46:47] neg_lo:[1,0,0] neg_hi:[1,0,0]
    v_cvt_pk_bf16_f32 v180, v40, v41
    v_cvt_pk_bf16_f32 v181, v42, v43
    v_cvt_pk_bf16_f32 v182, v44, v45
    v_cvt_pk_bf16_f32 v183, v46, v47
    buffer_store_dwordx4 v[180:183], v2, s[36:39], s48 offen offset:1024 sc1
    v_pk_fma_f32 v[24:25], v[72:73], v[90:91], v[8:9] op_sel:[0,1,0] op_sel_hi:[1,1,1]
    v_pk_fma_f32 v[26:27], v[74:75], v[90:91], v[10:11] op_sel:[0,1,0] op_sel_hi:[1,1,1]
    v_pk_fma_f32 v[28:29], v[76:77], v[90:91], v[12:13] op_sel:[0,1,0] op_sel_hi:[1,1,1]
    v_pk_fma_f32 v[30:31], v[78:79], v[90:91], v[14:15] op_sel:[0,1,0] op_sel_hi:[1,1,1]
    v_pk_fma_f32 v[48:49], v[48:49], v[90:91], v[24:25] op_sel:[0,0,0] op_sel_hi:[1,0,1]
    v_pk_fma_f32 v[50:51], v[50:51], v[90:91], v[26:27] op_sel:[0,0,0] op_sel_hi:[1,0,1]
    v_pk_fma_f32 v[52:53], v[52:53], v[90:91], v[28:29] op_sel:[0,0,0] op_sel_hi:[1,0,1]
    v_pk_fma_f32 v[54:55], v[54:55], v[90:91], v[30:31] op_sel:[0,0,0] op_sel_hi:[1,0,1]
    v_exp_f32 v24, v48
    v_exp_f32 v25, v49
    v_exp_f32 v26, v50
    v_exp_f32 v27, v51
    v_exp_f32 v28, v52
    v_exp_f32 v29, v53
    v_exp_f32 v30, v54
    v_exp_f32 v31, v55
    v_pk_fma_f32 v[64:65], v[24:25], s[60:61], 1.0 op_sel_hi:[1,1,0]
    v_pk_fma_f32 v[66:67], v[26:27], s[60:61], 1.0 op_sel_hi:[1,1,0]
    v_pk_fma_f32 v[68:69], v[28:29], s[60:61], 1.0 op_sel_hi:[1,1,0]
    v_pk_fma_f32 v[70:71], v[30:31], s[60:61], 1.0 op_sel_hi:[1,1,0]
    v_pk_fma_f32 v[64:65], v[24:25], v[64:65], 1.0 op_sel_hi:[1,1,0]
    v_pk_fma_f32 v[66:67], v[26:27], v[66:67], 1.0 op_sel_hi:[1,1,0]
    v_pk_fma_f32 v[68:69], v[28:29], v[68:69], 1.0 op_sel_hi:[1,1,0]
    v_pk_fma_f32 v[70:71], v[30:31], v[70:71], 1.0 op_sel_hi:[1,1,0]
    v_rcp_f32 v64, v64
    v_rcp_f32 v65, v65
    v_rcp_f32 v66, v66
    v_rcp_f32 v67, v67
    v_rcp_f32 v68, v68
    v_rcp_f32 v69, v69
    v_rcp_f32 v70, v70
    v_rcp_f32 v71, v71
    v_pk_fma_f32 v[48:49], v[48:49], v[64:65], v[48:49] neg_lo:[1,0,0] neg_hi:[1,0,0]
    v_pk_fma_f32 v[50:51], v[50:51], v[66:67], v[50:51] neg_lo:[1,0,0] neg_hi:[1,0,0]
    v_pk_fma_f32 v[52:53], v[52:53], v[68:69], v[52:53] neg_lo:[1,0,0] neg_hi:[1,0,0]
    v_pk_fma_f32 v[54:55], v[54:55], v[70:71], v[54:55] neg_lo:[1,0,0] neg_hi:[1,0,0]
    v_cvt_pk_bf16_f32 v184, v48, v49
    v_cvt_pk_bf16_f32 v185, v50, v51
    v_cvt_pk_bf16_f32 v186, v52, v53
    v_cvt_pk_bf16_f32 v187, v54, v55
    buffer_store_dwordx4 v[184:187], v2, s[36:39], s49 offen offset:0 sc1
    v_pk_fma_f32 v[24:25], v[80:81], v[90:91], v[16:17] op_sel:[0,1,0] op_sel_hi:[1,1,1]
    v_pk_fma_f32 v[26:27], v[82:83], v[90:91], v[18:19] op_sel:[0,1,0] op_sel_hi:[1,1,1]
    v_pk_fma_f32 v[28:29], v[84:85], v[90:91], v[20:21] op_sel:[0,1,0] op_sel_hi:[1,1,1]
    v_pk_fma_f32 v[30:31], v[86:87], v[90:91], v[22:23] op_sel:[0,1,0] op_sel_hi:[1,1,1]
    v_pk_fma_f32 v[56:57], v[56:57], v[90:91], v[24:25] op_sel:[0,0,0] op_sel_hi:[1,0,1]
    v_pk_fma_f32 v[58:59], v[58:59], v[90:91], v[26:27] op_sel:[0,0,0] op_sel_hi:[1,0,1]
    v_pk_fma_f32 v[60:61], v[60:61], v[90:91], v[28:29] op_sel:[0,0,0] op_sel_hi:[1,0,1]
    v_pk_fma_f32 v[62:63], v[62:63], v[90:91], v[30:31] op_sel:[0,0,0] op_sel_hi:[1,0,1]
    v_exp_f32 v24, v56
    v_exp_f32 v25, v57
    v_exp_f32 v26, v58
    v_exp_f32 v27, v59
    v_exp_f32 v28, v60
    v_exp_f32 v29, v61
    v_exp_f32 v30, v62
    v_exp_f32 v31, v63
    v_pk_fma_f32 v[64:65], v[24:25], s[60:61], 1.0 op_sel_hi:[1,1,0]
    v_pk_fma_f32 v[66:67], v[26:27], s[60:61], 1.0 op_sel_hi:[1,1,0]
    v_pk_fma_f32 v[68:69], v[28:29], s[60:61], 1.0 op_sel_hi:[1,1,0]
    v_pk_fma_f32 v[70:71], v[30:31], s[60:61], 1.0 op_sel_hi:[1,1,0]
    v_pk_fma_f32 v[64:65], v[24:25], v[64:65], 1.0 op_sel_hi:[1,1,0]
    v_pk_fma_f32 v[66:67], v[26:27], v[66:67], 1.0 op_sel_hi:[1,1,0]
    v_pk_fma_f32 v[68:69], v[28:29], v[68:69], 1.0 op_sel_hi:[1,1,0]
    v_pk_fma_f32 v[70:71], v[30:31], v[70:71], 1.0 op_sel_hi:[1,1,0]
    v_rcp_f32 v64, v64
    v_rcp_f32 v65, v65
    v_rcp_f32 v66, v66
    v_rcp_f32 v67, v67
    v_rcp_f32 v68, v68
    v_rcp_f32 v69, v69
    v_rcp_f32 v70, v70
    v_rcp_f32 v71, v71
    v_pk_fma_f32 v[56:57], v[56:57], v[64:65], v[56:57] neg_lo:[1,0,0] neg_hi:[1,0,0]
    v_pk_fma_f32 v[58:59], v[58:59], v[66:67], v[58:59] neg_lo:[1,0,0] neg_hi:[1,0,0]
    v_pk_fma_f32 v[60:61], v[60:61], v[68:69], v[60:61] neg_lo:[1,0,0] neg_hi:[1,0,0]
    v_pk_fma_f32 v[62:63], v[62:63], v[70:71], v[62:63] neg_lo:[1,0,0] neg_hi:[1,0,0]
    v_cvt_pk_bf16_f32 v188, v56, v57
    v_cvt_pk_bf16_f32 v189, v58, v59
    v_cvt_pk_bf16_f32 v190, v60, v61
    v_cvt_pk_bf16_f32 v191, v62, v63
    buffer_store_dwordx4 v[188:191], v2, s[36:39], s49 offen offset:1024 sc1
L_g1_done:
    s_nop 3
    s_lshl_b32 s3, s41, 3
    s_add_u32 s3, s3, s40
    s_lshl_b32 s3, s3, 3
    s_add_u32 s3, s3, s42
    s_lshl_b32 s3, s3, 2
    s_add_u32 s3, s3, 0x35000
    s_waitcnt vmcnt(0)
    s_cmp_eq_u32 s101, 0
    s_cbranch_scc1 L_sl_27
    v_mov_b32 v72, s100
    s_mov_b64 exec, 1
    buffer_store_dword v72, off, s[36:39], s3
    s_mov_b64 exec, -1
    s_branch L_dn_28
L_sl_27:
    v_mov_b32 v72, s100
    s_mov_b64 exec, 1
    buffer_store_dword v72, off, s[36:39], s3 sc1
    s_mov_b64 exec, -1
L_dn_28:
    s_lshl_b32 s3, s41, 3
    s_add_u32 s3, s3, s42
    s_mul_i32 s18, s3, 28672
    s_add_u32 s18, s18, 0xb00000
    s_add_u32 s19, s18, 14336
    s_lshl_b32 s3, s3, 5
    s_add_u32 s3, s3, 0x35000
    v_and_b32 v73, 7, v1
    v_lshlrev_b32 v73, 2, v73
    s_mov_b32 s43, 131072
L_poll_29:
    buffer_load_dword v72, v73, s[36:39], s3 offen sc1
    s_waitcnt vmcnt(0)
    v_cmp_ne_u32 vcc, s100, v72
    s_cbranch_vccz L_pd_30
    s_sub_u32 s43, s43, 1
    s_cmp_lg_u32 s43, 0
    s_cbranch_scc1 L_poll_29
L_pd_30:
    buffer_load_dwordx4 v[176:179], v2, s[36:39], s18 offen offset:0 sc1
    buffer_load_dwordx4 v[180:183], v2, s[36:39], s19 offen offset:0 sc1
    buffer_load_dwordx4 v[184:187], v2, s[36:39], s18 offen offset:1024 sc1
    buffer_load_dwordx4 v[188:191], v2, s[36:39], s19 offen offset:1024 sc1
    buffer_load_dwordx4 v[192:195], v2, s[36:39], s18 offen offset:2048 sc1
    buffer_load_dwordx4 v[196:199], v2, s[36:39], s19 offen offset:2048 sc1
    buffer_load_dwordx4 v[200:203], v2, s[36:39], s18 offen offset:3072 sc1
    buffer_load_dwordx4 v[204:207], v2, s[36:39], s19 offen offset:3072 sc1
    s_add_u32 s18, s18, 4096
    buffer_load_dwordx4 v[208:211], v2, s[36:39], s18 offen offset:0 sc1
    s_add_u32 s19, s19, 4096
    buffer_load_dwordx4 v[212:215], v2, s[36:39], s19 offen offset:0 sc1
    buffer_load_dwordx4 v[216:219], v2, s[36:39], s18 offen offset:1024 sc1
    buffer_load_dwordx4 v[220:223], v2, s[36:39], s19 offen offset:1024 sc1
    s_waitcnt vmcnt(11)
    v_mfma_f32_32x32x16_bf16 v[8:23], v[224:227], v[176:179], 0
    v_mfma_f32_32x32x16_bf16 v[40:55], v[120:123], v[176:179], 0
    buffer_load_dwordx4 v[176:179], v2, s[36:39], s18 offen offset:2048 sc1
    s_waitcnt vmcnt(11)
    v_mfma_f32_32x32x16_bf16 v[24:39], v[224:227], v[180:183], 0
    v_mfma_f32_32x32x16_bf16 v[56:71], v[120:123], v[180:183], 0
    buffer_load_dwordx4 v[180:183], v2, s[36:39], s19 offen offset:2048 sc1
    s_waitcnt vmcnt(11)
    v_mfma_f32_32x32x16_bf16 v[8:23], v[228:231], v[184:187], v[8:23]
    v_mfma_f32_32x32x16_bf16 v[40:55], v[124:127], v[184:187], v[40:55]
    buffer_load_dwordx4 v[184:187], v2, s[36:39], s18 offen offset:3072 sc1
    s_waitcnt vmcnt(11)
    v_mfma_f32_32x32x16_bf16 v[24:39], v[228:231], v[188:191], v[24:39]
    v_mfma_f32_32x32x16_bf16 v[56:71], v[124:127], v[188:191], v[56:71]
    buffer_load_dwordx4 v[188:191], v2, s[36:39], s19 offen offset:3072 sc1
    s_waitcnt vmcnt(11)
    v_mfma_f32_32x32x16_bf16 v[8:23], v[232:235], v[192:195], v[8:23]
    v_mfma_f32_32x32x16_bf16 v[40:55], v[128:131], v[192:195], v[40:55]
    s_add_u32 s18, s18, 4096
    buffer_load_dwordx4 v[192:195], v2, s[36:39], s18 offen offset:0 sc1
    s_waitcnt vmcnt(11)
    v_mfma_f32_32x32x16_bf16 v[24:39], v[232:235], v[196:199], v[24:39]
    v_mfma_f32_32x32x16_bf16 v[56:71], v[128:131], v[196:199], v[56:71]
    s_add_u32 s19, s19, 4096
    buffer_load_dwordx4 v[196:199], v2, s[36:39], s19 offen offset:0 sc1
    s_waitcnt vmcnt(11)
    v_mfma_f32_32x32x16_bf16 v[8:23], v[236:239], v[200:203], v[8:23]
    v_mfma_f32_32x32x16_bf16 v[40:55], v[132:135], v[200:203], v[40:55]
    buffer_load_dwordx4 v[200:203], v2, s[36:39], s18 offen offset:1024 sc1
    s_waitcnt vmcnt(11)
    v_mfma_f32_32x32x16_bf16 v[24:39], v[236:239], v[204:207], v[24:39]
    v_mfma_f32_32x32x16_bf16 v[56:71], v[132:135], v[204:207], v[56:71]
    buffer_load_dwordx4 v[204:207], v2, s[36:39], s19 offen offset:1024 sc1
    s_waitcnt vmcnt(11)
    v_mfma_f32_32x32x16_bf16 v[8:23], v[240:243], v[208:211], v[8:23]
    v_mfma_f32_32x32x16_bf16 v[40:55], v[136:139], v[208:211], v[40:55]
    buffer_load_dwordx4 v[208:211], v2, s[36:39], s18 offen offset:2048 sc1
    s_waitcnt vmcnt(11)
    v_mfma_f32_32x32x16_bf16 v[24:39], v[240:243], v[212:215], v[24:39]
    v_mfma_f32_32x32x16_bf16 v[56:71], v[136:139], v[212:215], v[56:71]
    buffer_load_dwordx4 v[212:215], v2, s[36:39], s19 offen offset:2048 sc1
    s_waitcnt vmcnt(11)
    v_mfma_f32_32x32x16_bf16 v[8:23], v[244:247], v[216:219], v[8:23]
    v_mfma_f32_32x32x16_bf16 v[40:55], v[140:143], v[216:219], v[40:55]
    buffer_load_dwordx4 v[216:219], v2, s[36:39], s18 offen offset:3072 sc1
    s_waitcnt vmcnt(11)
    v_mfma_f32_32x32x16_bf16 v[24:39], v[244:247], v[220:223], v[24:39]
    v_mfma_f32_32x32x16_bf16 v[56:71], v[140:143], v[220:223], v[56:71]
    buffer_load_dwordx4 v[220:223], v2, s[36:39], s19 offen offset:3072 sc1
    s_waitcnt vmcnt(11)
    v_mfma_f32_32x32x16_bf16 v[8:23], v[248:251], v[176:179], v[8:23]
    v_mfma_f32_32x32x16_bf16 v[40:55], v[144:147], v[176:179], v[40:55]
    s_add_u32 s18, s18, 4096
    buffer_load_dwordx4 v[176:179], v2, s[36:39], s18 offen offset:0 sc1
    s_waitcnt vmcnt(11)
    v_mfma_f32_32x32x16_bf16 v[24:39], v[248:251], v[180:183], v[24:39]
    v_mfma_f32_32x32x16_bf16 v[56:71], v[144:147], v[180:183], v[56:71]
    s_add_u32 s19, s19, 4096
    buffer_load_dwordx4 v[180:183], v2, s[36:39], s19 offen offset:0 sc1
    s_waitcnt vmcnt(11)
    v_mfma_f32_32x32x16_bf16 v[8:23], v[252:255], v[184:187], v[8:23]
    v_mfma_f32_32x32x16_bf16 v[40:55], v[148:151], v[184:187], v[40:55]
    buffer_load_dwordx4 v[184:187], v2, s[36:39], s18 offen offset:1024 sc1
    s_waitcnt vmcnt(11)
    v_mfma_f32_32x32x16_bf16 v[24:39], v[252:255], v[188:191], v[24:39]
    v_mfma_f32_32x32x16_bf16 v[56:71], v[148:151], v[188:191], v[56:71]
    buffer_load_dwordx4 v[188:191], v2, s[36:39], s19 offen offset:1024 sc1
    s_waitcnt vmcnt(11)
    v_mfma_f32_32x32x16_bf16 v[8:23], v[96:99], v[192:195], v[8:23]
    v_mfma_f32_32x32x16_bf16 v[40:55], v[152:155], v[192:195], v[40:55]
    s_waitcnt vmcnt(10)
    v_mfma_f32_32x32x16_bf16 v[24:39], v[96:99], v[196:199], v[24:39]
    v_mfma_f32_32x32x16_bf16 v[56:71], v[152:155], v[196:199], v[56:71]
    s_waitcnt vmcnt(9)
    v_mfma_f32_32x32x16_bf16 v[8:23], v[100:103], v[200:203], v[8:23]
    v_mfma_f32_32x32x16_bf16 v[40:55], v[156:159], v[200:203], v[40:55]
    s_waitcnt vmcnt(8)
    v_mfma_f32_32x32x16_bf16 v[24:39], v[100:103], v[204:207], v[24:39]
    v_mfma_f32_32x32x16_bf16 v[56:71], v[156:159], v[204:207], v[56:71]
    s_waitcnt vmcnt(7)
    v_mfma_f32_32x32x16_bf16 v[8:23], v[104:107], v[208:211], v[8:23]
    v_mfma_f32_32x32x16_bf16 v[40:55], v[160:163], v[208:211], v[40:55]
    s_waitcnt vmcnt(6)
    v_mfma_f32_32x32x16_bf16 v[24:39], v[104:107], v[212:215], v[24:39]
    v_mfma_f32_32x32x16_bf16 v[56:71], v[160:163], v[212:215], v[56:71]
    s_waitcnt vmcnt(5)
    v_mfma_f32_32x32x16_bf16 v[8:23], v[108:111], v[216:219], v[8:23]
    v_mfma_f32_32x32x16_bf16 v[40:55], v[164:167], v[216:219], v[40:55]
    s_waitcnt vmcnt(4)
    v_mfma_f32_32x32x16_bf16 v[24:39], v[108:111], v[220:223], v[24:39]
    v_mfma_f32_32x32x16_bf16 v[56:71], v[164:167], v[220:223], v[56:71]
    s_waitcnt vmcnt(3)
    v_mfma_f32_32x32x16_bf16 v[8:23], v[112:115], v[176:179], v[8:23]
    v_mfma_f32_32x32x16_bf16 v[40:55], v[168:171], v[176:179], v[40:55]
    s_waitcnt vmcnt(2)
    v_mfma_f32_32x32x16_bf16 v[24:39], v[112:115], v[180:183], v[24:39]
    v_mfma_f32_32x32x16_bf16 v[56:71], v[168:171], v[180:183], v[56:71]
    s_waitcnt vmcnt(1)
    v_mfma_f32_32x32x16_bf16 v[8:23], v[116:119], v[184:187], v[8:23]
    v_mfma_f32_32x32x16_bf16 v[40:55], v[172:175], v[184:187], v[40:55]
    s_waitcnt vmcnt(0)
    v_mfma_f32_32x32x16_bf16 v[24:39], v[116:119], v[188:191], v[24:39]
    v_mfma_f32_32x32x16_bf16 v[56:71], v[172:175], v[188:191], v[56:71]
L_g2_done:
    s_nop 1
    s_lshr_b32 s48, s42, 2
    s_lshl_b32 s48, s48, 2
    s_and_b32 s49, s42, 1
    s_lshl_b32 s49, s49, 1
    s_bfe_u32 s50, s42, 0x10001
    s_add_u32 s48, s48, s49
    s_add_u32 s48, s48, s50
    s_lshl_b32 s3, s42, 11
    v_add_u32 v72, s3, v2
    v_add_u32 v73, 0x10000, v72
    s_nop 11
    s_cmp_eq_u32 s48, 0
    s_cbranch_scc1 L_own_31
    ds_write_b128 v72, v[8:11] offset:0
    ds_write_b128 v72, v[12:15] offset:1024
    s_branch L_nx_32
L_own_31:
    v_mov_b32 v80, v8
    v_mov_b32 v81, v9
    v_mov_b32 v82, v10
    v_mov_b32 v83, v11
    v_mov_b32 v84, v12
    v_mov_b32 v85, v13
    v_mov_b32 v86, v14
    v_mov_b32 v87, v15
L_nx_32:
    s_cmp_eq_u32 s48, 1
    s_cbranch_scc1 L_own_33
    ds_write_b128 v72, v[16:19] offset:16384
    ds_write_b128 v72, v[20:23] offset:17408
    s_branch L_nx_34
L_own_33:
    v_mov_b32 v80, v16
    v_mov_b32 v81, v17
    v_mov_b32 v82, v18
    v_mov_b32 v83, v19
    v_mov_b32 v84, v20
    v_mov_b32 v85, v21
    v_mov_b32 v86, v22
    v_mov_b32 v87, v23
L_nx_34:
    s_cmp_eq_u32 s48, 2
    s_cbranch_scc1 L_own_35
    ds_write_b128 v72, v[24:27] offset:32768
    ds_write_b128 v72, v[28:31] offset:33792
    s_branch L_nx_36
L_own_35:
    v_mov_b32 v80, v24
    v_mov_b32 v81, v25
    v_mov_b32 v82, v26
    v_mov_b32 v83, v27
    v_mov_b32 v84, v28
    v_mov_b32 v85, v29
    v_mov_b32 v86, v30
    v_mov_b32 v87, v31
L_nx_36:
    s_cmp_eq_u32 s48, 3
    s_cbranch_scc1 L_own_37
    ds_write_b128 v72, v[32:35] offset:49152
    ds_write_b128 v72, v[36:39] offset:50176
    s_branch L_nx_38
L_own_37:
    v_mov_b32 v80, v32
    v_mov_b32 v81, v33
    v_mov_b32 v82, v34
    v_mov_b32 v83, v35
    v_mov_b32 v84, v36
    v_mov_b32 v85, v37
    v_mov_b32 v86, v38
    v_mov_b32 v87, v39
L_nx_38:
    s_cmp_eq_u32 s48, 4
    s_cbranch_scc1 L_own_39
    ds_write_b128 v73, v[40:43] offset:0
    ds_write_b128 v73, v[44:47] offset:1024
    s_branch L_nx_40
L_own_39:
    v_mov_b32 v80, v40
    v_mov_b32 v81, v41
    v_mov_b32 v82, v42
    v_mov_b32 v83, v43
    v_mov_b32 v84, v44
    v_mov_b32 v85, v45
    v_mov_b32 v86, v46
    v_mov_b32 v87, v47
L_nx_40:
    s_cmp_eq_u32 s48, 5
    s_cbranch_scc1 L_own_41
    ds_write_b128 v73, v[48:51] offset:16384
    ds_write_b128 v73, v[52:55] offset:17408
    s_branch L_nx_42
L_own_41:
    v_mov_b32 v80, v48
    v_mov_b32 v81, v49
    v_mov_b32 v82, v50
    v_mov_b32 v83, v51
    v_mov_b32 v84, v52
    v_mov_b32 v85, v53
    v_mov_b32 v86, v54
    v_mov_b32 v87, v55
L_nx_42:
    s_cmp_eq_u32 s48, 6
    s_cbranch_scc1 L_own_43
    ds_write_b128 v73, v[56:59] offset:32768
    ds_write_b128 v73, v[60:63] offset:33792
    s_branch L_nx_44
L_own_43:
    v_mov_b32 v80, v56
    v_mov_b32 v81, v57
    v_mov_b32 v82, v58
    v_mov_b32 v83, v59
    v_mov_b32 v84, v60
    v_mov_b32 v85, v61
    v_mov_b32 v86, v62
    v_mov_b32 v87, v63
L_nx_44:
    s_cmp_eq_u32 s48, 7
    s_cbranch_scc1 L_own_45
    ds_write_b128 v73, v[64:67] offset:49152
    ds_write_b128 v73, v[68:71] offset:50176
    s_branch L_nx_46
L_own_45:
    v_mov_b32 v80, v64
    v_mov_b32 v81, v65
    v_mov_b32 v82, v66
    v_mov_b32 v83, v67
    v_mov_b32 v84, v68
    v_mov_b32 v85, v69
    v_mov_b32 v86, v70
    v_mov_b32 v87, v71
L_nx_46:
    s_lshl_b32 s3, s48, 14
    v_add_u32 v74, s3, v2
    v_lshlrev_b32 v88, 16, v4
    v_and_b32 v89, 0xffff0000, v4
    v_lshlrev_b32 v90, 16, v5
    v_and_b32 v91, 0xffff0000, v5
    v_lshlrev_b32 v92, 16, v6
    v_and_b32 v93, 0xffff0000, v6
    v_lshlrev_b32 v94, 16, v7
    v_and_b32 v95, 0xffff0000, v7
    s_waitcnt lgkmcnt(0)
    s_barrier
    s_add_u32 s3, s42, 1
    s_and_b32 s3, s3, 7
    s_lshl_b32 s3, s3, 11
    v_add_u32 v75, s3, v74
    ds_read_b128 v[8:11], v75
    ds_read_b128 v[12:15], v75 offset:1024
    s_add_u32 s3, s42, 2
    s_and_b32 s3, s3, 7
    s_lshl_b32 s3, s3, 11
    v_add_u32 v75, s3, v74
    ds_read_b128 v[16:19], v75
    ds_read_b128 v[20:23], v75 offset:1024
    s_add_u32 s3, s42, 3
    s_and_b32 s3, s3, 7
    s_lshl_b32 s3, s3, 11
    v_add_u32 v75, s3, v74
    ds_read_b128 v[24:27], v75
    ds_read_b128 v[28:31], v75 offset:1024
    s_add_u32 s3, s42, 4
    s_and_b32 s3, s3, 7
    s_lshl_b32 s3, s3, 11
    v_add_u32 v75, s3, v74
    ds_read_b128 v[32:35], v75
    ds_read_b128 v[36:39], v75 offset:1024
    s_add_u32 s3, s42, 5
    s_and_b32 s3, s3, 7
    s_lshl_b32 s3, s3, 11
    v_add_u32 v75, s3, v74
    ds_read_b128 v[40:43], v75
    ds_read_b128 v[44:47], v75 offset:1024
    s_add_u32 s3, s42, 6
    s_and_b32 s3, s3, 7
    s_lshl_b32 s3, s3, 11
    v_add_u32 v75, s3, v74
    ds_read_b128 v[48:51], v75
    ds_read_b128 v[52:55], v75 offset:1024
    s_add_u32 s3, s42, 7
    s_and_b32 s3, s3, 7
    s_lshl_b32 s3, s3, 11
    v_add_u32 v75, s3, v74
    ds_read_b128 v[56:59], v75
    ds_read_b128 v[60:63], v75 offset:1024
    s_waitcnt lgkmcnt(12)
    v_pk_add_f32 v[80:81], v[80:81], v[8:9]
    v_pk_add_f32 v[82:83], v[82:83], v[10:11]
    v_pk_add_f32 v[84:85], v[84:85], v[12:13]
    v_pk_add_f32 v[86:87], v[86:87], v[14:15]
    s_waitcnt lgkmcnt(10)
    v_pk_add_f32 v[80:81], v[80:81], v[16:17]
    v_pk_add_f32 v[82:83], v[82:83], v[18:19]
    v_pk_add_f32 v[84:85], v[84:85], v[20:21]
    v_pk_add_f32 v[86:87], v[86:87], v[22:23]
    s_waitcnt lgkmcnt(8)
    v_pk_add_f32 v[80:81], v[80:81], v[24:25]
    v_pk_add_f32 v[82:83], v[82:83], v[26:27]
    v_pk_add_f32 v[84:85], v[84:85], v[28:29]
    v_pk_add_f32 v[86:87], v[86:87], v[30:31]
    s_waitcnt lgkmcnt(6)
    v_pk_add_f32 v[80:81], v[80:81], v[32:33]
    v_pk_add_f32 v[82:83], v[82:83], v[34:35]
    v_pk_add_f32 v[84:85], v[84:85], v[36:37]
    v_pk_add_f32 v[86:87], v[86:87], v[38:39]
    s_waitcnt lgkmcnt(4)
    v_pk_add_f32 v[80:81], v[80:81], v[40:41]
    v_pk_add_f32 v[82:83], v[82:83], v[42:43]
    v_pk_add_f32 v[84:85], v[84:85], v[44:45]
    v_pk_add_f32 v[86:87], v[86:87], v[46:47]
    s_waitcnt lgkmcnt(2)
    v_pk_add_f32 v[80:81], v[80:81], v[48:49]
    v_pk_add_f32 v[82:83], v[82:83], v[50:51]
    v_pk_add_f32 v[84:85], v[84:85], v[52:53]
    v_pk_add_f32 v[86:87], v[86:87], v[54:55]
    s_waitcnt lgkmcnt(0)
    v_pk_add_f32 v[80:81], v[80:81], v[56:57]
    v_pk_add_f32 v[82:83], v[82:83], v[58:59]
    v_pk_add_f32 v[84:85], v[84:85], v[60:61]
    v_pk_add_f32 v[86:87], v[86:87], v[62:63]
    s_mov_b32 s3, 0x3f317218
    v_fma_f32 v80, v80, s3, v88
    v_fma_f32 v81, v81, s3, v89
    v_fma_f32 v82, v82, s3, v90
    v_fma_f32 v83, v83, s3, v91
    v_fma_f32 v84, v84, s3, v92
    v_fma_f32 v85, v85, s3, v93
    v_fma_f32 v86, v86, s3, v94
    v_fma_f32 v87, v87, s3, v95
    v_cvt_pk_bf16_f32 v8, v80, v81
    v_cvt_pk_bf16_f32 v9, v82, v83
    v_cvt_pk_bf16_f32 v10, v84, v85
    v_cvt_pk_bf16_f32 v11, v86, v87
    s_nop 0
    v_permlane32_swap_b32 v8, v10
    v_permlane32_swap_b32 v9, v11
    v_and_b32 v13, 31, v1
    v_lshrrev_b32 v14, 5, v1
    v_lshlrev_b32 v13, 10, v13
    v_lshl_add_u32 v13, v14, 4, v13
    buffer_store_dwordx4 v[8:11], v13, s[32:35], s53 offen
    s_cmp_lg_u32 s2, 0
    s_cbranch_scc1 L_ep_done
    s_cmp_lg_u32 s42, 0
    s_cbranch_scc1 L_ep_done
    s_mov_b32 s3, 0x37000
    v_mov_b32 v72, s16
    s_mov_b64 exec, 1
    buffer_store_dword v72, off, s[36:39], s3 sc1
    s_mov_b64 exec, -1
L_ep_done:
    s_waitcnt vmcnt(0)
L_end:
    s_endpgm
.section .rodata,"a"
.p2align 6
.amdhsa_kernel sequential_preLN__grouped_kv_mqa__dense_activation_mish__prompt_kernel
  .amdhsa_next_free_vgpr 256
  .amdhsa_next_free_sgpr 102
  .amdhsa_accum_offset 256
  .amdhsa_group_segment_fixed_size 0
  .amdhsa_kernarg_size 96
  .amdhsa_user_sgpr_count 2
  .amdhsa_user_sgpr_kernarg_segment_ptr 1
  .amdhsa_system_sgpr_workgroup_id_x 1
.end_amdhsa_kernel
```
